```python
import torch

def _softmax(x, axis=-1):
    return torch.softmax(x, dim=axis)

def _gelu(x):
    return torch.nn.functional.gelu(x, approximate='tanh')

def _silu(x):
    return torch.nn.functional.silu(x)

def _sigmoid(x):
    return torch.sigmoid(x)

def _layernorm(x, axis=-1, eps=1e-05):
    m = x.mean(dim=axis, keepdim=True)
    v = x.var(dim=axis, keepdim=True, unbiased=False)
    return (x - m) / torch.sqrt(v + eps)

def _scatter_add(tgt, idx, src, axis=0):
    return tgt.clone().index_add_(axis, idx, src)

def _segment_sum(src, seg, n):
    out = torch.zeros((n,) + src.shape[1:], dtype=src.dtype)
    return out.index_add_(0, seg, src)

def _pad(x, pw):
    flat = tuple((v for pair in reversed(pw) for v in pair))
    return torch.nn.functional.pad(x, flat)
kernel_name = 'standalone__autoregressive_conv_wavenet__speech'

def setup_inputs():

    _w = lambda a: (lambda t: t.to(torch.bfloat16) if t.is_floating_point() else t)(torch.as_tensor(a))
    B, T, D, K = (2, 16000, 256, 5)
    return {'x': _w((lambda *s: torch.randn(*s, dtype=torch.bfloat16) * 0.1)(B, T, D)), 'w': _w((lambda *s: torch.randn(*s, dtype=torch.bfloat16) * 0.1)(K, D, 2 * D)), 'w_o': _w((lambda *s: torch.randn(*s, dtype=torch.bfloat16) * 0.05)(D, D))}

def reference(x, w, w_o):
    B, T, D = x.shape
    K = w.shape[0]
    dil = 2
    pad = (K - 1) * dil
    xp = _pad(x, ((0, 0), (pad, 0), (0, 0)))
    h = torch.einsum('btc,cd->btd', xp[:, pad:pad + T, :], w[0])
    for i in range(1, K):
        off = pad - i * dil
        h = h + torch.einsum('btc,cd->btd', xp[:, off:off + T, :], w[i])
    f = h[..., :D].clone()
    g = h[..., D:].clone()
    z = torch.tanh(f) * _sigmoid(g)
    return z @ w_o
```

```asm
; @launch grid=(256,1,1) block=(512,1,1) lds=163840
.amdgcn_target "amdgcn-amd-amdhsa--gfx950"
.text
.globl standalone__autoregressive_conv_wavenet__speech_kernel
.p2align 8
.type standalone__autoregressive_conv_wavenet__speech_kernel,@function
standalone__autoregressive_conv_wavenet__speech_kernel:
    s_cmp_ge_u32 s2, 256
    s_cbranch_scc1 L_END
    s_load_dwordx4 s[32:35], s[0:1], 0
    s_load_dwordx4 s[36:39], s[0:1], 16
    s_load_dwordx4 s[40:43], s[0:1], 32
    v_lshrrev_b32 v250, 6, v0
    v_and_b32 v251, 63, v0
    v_readfirstlane_b32 s28, v250
    v_lshlrev_b32 v247, 4, v251
    v_and_b32 v248, 15, v0
    v_bfe_u32 v249, v0, 4, 2
    s_and_b32 s31, s28, 3
    v_mov_b32 v12, 0
    v_mov_b32 v13, 0
    v_mov_b32 v14, 0
    v_mov_b32 v15, 0
    v_mov_b32 v16, 163584
    ds_write_b128 v16, v[12:15]
    ds_write_b128 v16, v[12:15] offset:16
    s_waitcnt lgkmcnt(0)
    s_mov_b32 s4, s32
    s_mov_b32 s5, s33
    s_mov_b32 s6, 16384000
    s_mov_b32 s7, 0x00020000
    s_mov_b32 s8, s34
    s_mov_b32 s9, s35
    s_mov_b32 s10, 1310720
    s_mov_b32 s11, 0x00020000
    s_mov_b32 s12, s36
    s_mov_b32 s13, s37
    s_mov_b32 s14, 131072
    s_mov_b32 s15, 0x00020000
    s_mov_b32 s16, s38
    s_mov_b32 s17, s39
    s_mov_b32 s18, 16384000
    s_mov_b32 s19, 0x00020000
    s_mov_b32 s24, s40
    s_mov_b32 s25, s41
    s_mov_b32 s26, 256
    s_mov_b32 s27, 0x00020000
    s_mov_b32 s20, s42
    s_mov_b32 s21, s43
    s_mov_b32 s22, 13107200
    s_mov_b32 s23, 0x00020000
    s_lshr_b32 s44, s2, 4
    s_lshl_b32 s44, s44, 3
    s_and_b32 s45, s2, 7
    s_add_u32 s30, s44, s45
    s_bfe_u32 s29, s2, 0x10003
    s_lshl_b32 s44, s30, 1
    s_add_u32 s53, s44, s29
    s_xor_b32 s52, s53, 1
    s_cmp_ge_u32 s28, 4
    s_cbranch_scc1 L_XL
    s_and_b32 s44, s2, 7
    s_lshl_b32 s44, s44, 7
    s_bfe_u32 s45, s2, 0x30003
    s_lshl_b32 s45, s45, 15
    s_add_u32 s44, s44, s45
    v_lshrrev_b32 v92, 3, v0
    v_and_b32 v93, 7, v0
    v_lshlrev_b32 v93, 4, v93
    v_lshl_add_u32 v94, v92, 10, v93
    buffer_load_dwordx4 v[0:3], v94, s[8:11], s44 offen
    s_add_u32 s44, s44, 262144
    buffer_load_dwordx4 v[4:7], v94, s[8:11], s44 offen
    s_add_u32 s44, s44, 262144
    buffer_load_dwordx4 v[8:11], v94, s[8:11], s44 offen
    s_add_u32 s44, s44, 262144
    buffer_load_dwordx4 v[12:15], v94, s[8:11], s44 offen
    s_add_u32 s44, s44, 262144
    buffer_load_dwordx4 v[16:19], v94, s[8:11], s44 offen
    s_barrier
    s_setprio 2
    s_and_b32 s44, s2, 63
    s_lshr_b32 s45, s44, 1
    s_and_b32 s46, s44, 1
    s_lshl_b32 s47, s45, 12
    s_lshl_b32 s48, s46, 8
    s_add_u32 s47, s47, s48
    v_lshrrev_b32 v94, 2, v247
    s_lshr_b32 s48, s2, 6
    s_lshl_b32 s48, s48, 2
    s_add_u32 s48, s48, s28
    s_cmp_lg_u32 s48, 8
    s_cbranch_scc1 L_NOWOL
    buffer_load_dword v84, v94, s[12:15], s47 offen offset:0
    buffer_load_dword v85, v94, s[12:15], s47 offen offset:512
    buffer_load_dword v86, v94, s[12:15], s47 offen offset:1024
    buffer_load_dword v87, v94, s[12:15], s47 offen offset:1536
    buffer_load_dword v88, v94, s[12:15], s47 offen offset:2048
    buffer_load_dword v89, v94, s[12:15], s47 offen offset:2560
    buffer_load_dword v90, v94, s[12:15], s47 offen offset:3072
    buffer_load_dword v91, v94, s[12:15], s47 offen offset:3584
L_NOWOL:
    v_mov_b32 v96, 0
    s_lshl_b32 s44, s2, 10
    s_lshl_b32 s45, s31, 8
    s_add_u32 s44, s44, s45
    s_add_u32 s44, s44, 12845056
    v_lshlrev_b32 v97, 3, v247
    s_mov_b64 exec, 3
    buffer_store_dword v96, v97, s[20:23], s44 offen sc1
    s_mov_b64 exec, -1
    v_bfe_u32 v95, v92, 1, 2
    v_lshlrev_b32 v95, 5, v95
    v_xor_b32 v95, v95, v93
    v_lshl_add_u32 v95, v92, 7, v95
    v_add_u32 v95, 139264, v95
    v_mov_b32 v203, 0
    v_mov_b32 v205, 0
    v_mov_b32 v206, 0
    v_mov_b32 v207, 0
    v_mov_b32 v208, 0
    s_mov_b32 s56, 0
    s_mov_b32 s57, 0
    s_branch L_SET
L_XL:
    s_cmp_ge_u32 s30, 125
    s_cbranch_scc1 L_END
    s_barrier
    v_bfe_u32 v200, v251, 2, 1
    v_lshrrev_b32 v201, 3, v251
    v_and_b32 v202, 3, v251
    v_lshlrev_b32 v202, 4, v202
    v_lshl_add_u32 v203, v200, 9, v202
    v_lshl_add_u32 v203, v201, 6, v203
    s_lshl_b32 s47, s30, 1
    s_or_b32 s48, s47, 1
    s_lshl_b32 s45, s47, 16
    s_lshl_b32 s46, s31, 10
    s_add_u32 s45, s45, s46
    s_sub_u32 s46, s45, 4096
    s_cmp_eq_u32 s47, 0
    s_cselect_b32 s46, 0x80000000, s46
    s_cmp_eq_u32 s47, 125
    s_cselect_b32 s46, 0x80000000, s46
    v_add_u32 v205, s46, v203
    s_mov_b32 s56, s45
    s_lshl_b32 s45, s48, 16
    s_lshl_b32 s46, s31, 10
    s_add_u32 s45, s45, s46
    s_sub_u32 s46, s45, 4096
    s_cmp_eq_u32 s48, 0
    s_cselect_b32 s46, 0x80000000, s46
    s_cmp_eq_u32 s48, 125
    s_cselect_b32 s46, 0x80000000, s46
    v_add_u32 v208, s46, v203
    s_mov_b32 s57, s45
    buffer_load_dwordx4 v[0:3], v205, s[4:7], 0 offen nt
    buffer_load_dwordx4 v[4:7], v203, s[4:7], s56 offen nt
    s_add_u32 s56, s56, 4096
    buffer_load_dwordx4 v[8:11], v203, s[4:7], s56 offen nt
    s_add_u32 s56, s56, 4096
    buffer_load_dwordx4 v[12:15], v203, s[4:7], s56 offen nt
    s_add_u32 s56, s56, 4096
    buffer_load_dwordx4 v[16:19], v203, s[4:7], s56 offen nt
    s_add_u32 s56, s56, 4096
    buffer_load_dwordx4 v[20:23], v203, s[4:7], s56 offen nt
    s_add_u32 s56, s56, 4096
    s_mov_b32 s46, 17408
    v_mul_lo_u32 v206, v201, s46
    v_lshl_add_u32 v206, v200, 6, v206
    v_add_u32 v206, v206, v202
    s_lshl_b32 s46, s31, 7
    s_cmp_eq_u32 s29, 0
    s_cselect_b32 s47, 8704, 0
    s_add_u32 s46, s46, s47
    v_add_u32 v206, s46, v206
    v_xor_b32 v207, 32, v206
L_SET:
    s_lshl_b32 s45, s29, 3
    s_add_u32 s45, s45, s28
    s_lshl_b32 s46, s45, 10
    v_add_u32 v246, s46, v247
    s_lshl_b32 s47, s29, 2
    v_mov_b32 v252, s47
    v_and_b32 v253, 3, v251
    v_min_u32 v253, 2, v253
    v_lshlrev_b32 v253, 2, v253
    s_lshr_b32 s45, s45, 2
    s_lshl_b32 s45, s45, 10
    s_add_u32 s45, s45, 2097152
    v_lshrrev_b32 v224, 3, v248
    v_lshlrev_b32 v224, 12, v224
    v_add_u32 v224, s45, v224
    v_and_b32 v225, 7, v248
    v_lshl_add_u32 v254, v225, 7, v224
    v_add_u32 v225, 7, v248
    v_and_b32 v225, 7, v225
    v_lshl_add_u32 v255, v225, 7, v224
    s_lshl_b32 s46, s28, 14
    s_lshl_b32 s47, s29, 13
    s_add_u32 s46, s46, 2162688
    s_add_u32 s32, s46, s47
    s_add_u32 s33, s32, 4096
    s_xor_b32 s34, s32, 8192
    s_xor_b32 s35, s33, 8192
    s_lshl_b32 s46, s2, 15
    s_lshl_b32 s47, s28, 12
    s_add_u32 s46, s46, s47
    s_add_u32 s36, s46, 4194304
    s_xor_b32 s37, s36, 262144
    s_lshl_b32 s38, s53, 16
    s_mov_b32 s40, 0x41f00000
    v_mov_b32 v226, 0
    s_mov_b32 s46, 0xf6010200
    v_writelane_b32 v226, s46, 0
    s_mov_b32 s46, 0x000408fb
    v_writelane_b32 v226, s46, 1
    s_mov_b32 s46, 0x0a01fe00
    v_writelane_b32 v226, s46, 2
    s_mov_b32 s46, 0x0004f8fb
    v_writelane_b32 v226, s46, 3
    s_mov_b32 s46, 0xf6100800
    v_writelane_b32 v226, s46, 4
    s_mov_b32 s46, 0x000402ec
    v_writelane_b32 v226, s46, 5
    s_mov_b32 s46, 0x0a10f800
    v_writelane_b32 v226, s46, 6
    s_mov_b32 s46, 0x0004feec
    v_writelane_b32 v226, s46, 7
    s_mov_b32 s46, 0xef040400
    v_writelane_b32 v226, s46, 8
    s_mov_b32 s46, 0x000404ef
    v_writelane_b32 v226, s46, 9
    s_mov_b32 s46, 0x1104fc00
    v_writelane_b32 v226, s46, 10
    s_mov_b32 s46, 0x0004fcef
    v_writelane_b32 v226, s46, 11
    s_mov_b32 s46, 0x001500fc
    v_writelane_b32 v226, s46, 12
    s_mov_b32 s46, 0x000400eb
    v_writelane_b32 v226, s46, 13
    s_mov_b32 s46, 0x1500fc00
    v_writelane_b32 v226, s46, 14
    s_mov_b32 s46, 0x0400eb00
    v_writelane_b32 v226, s46, 15
    v_bfe_u32 v227, v248, 1, 1
    v_sub_u32 v228, v249, v227
    v_lshrrev_b32 v229, 2, v248
    v_lshl_add_u32 v229, v229, 1, v228
    v_lshlrev_b32 v229, 2, v229
    v_cmp_lt_u32 vcc, v228, 2
    v_mov_b32 v227, 192
    s_nop 0
    v_cndmask_b32 v229, v227, v229, vcc
    ds_bpermute_b32 v230, v229, v226 offset:0
    ds_bpermute_b32 v231, v229, v226 offset:32
    v_and_b32 v239, 1, v248
    v_lshlrev_b32 v239, 4, v239
    v_xor_b32 v239, 16, v239
    v_add_u32 v240, 139264, v247
    v_xor_b32 v241, 64, v240
    v_min_u32 v224, 2, v249
    v_lshrrev_b32 v225, 2, v248
    v_lshl_add_u32 v225, v224, 3, v225
    s_lshl_b32 s46, s28, 4
    v_add_u32 v225, s46, v225
    v_lshlrev_b32 v242, 6, v225
    v_and_b32 v224, 1, v224
    v_lshl_add_u32 v242, v224, 5, v242
    v_and_b32 v224, 3, v248
    v_lshl_add_u32 v242, v224, 3, v242
    v_xor_b32 v243, 32, v242
    v_lshrrev_b32 v225, 2, v248
    v_lshlrev_b32 v245, 11, v225
    v_lshl_add_u32 v245, v249, 8, v245
    s_lshl_b32 s46, s31, 2
    v_add_u32 v224, s46, v224
    v_and_b32 v225, 1, v225
    v_lshlrev_b32 v225, 2, v225
    v_xor_b32 v224, v224, v225
    v_lshl_add_u32 v245, v224, 4, v245
    s_lshr_b32 s46, s28, 2
    s_lshl_b32 s46, s46, 10
    v_add_u32 v245, s46, v245
    v_add_u32 v244, 139264, v245
    s_waitcnt lgkmcnt(1)
    v_bfe_i32 v216, v230, 0, 8
    v_cvt_f32_i32 v216, v216
    v_bfe_i32 v217, v230, 8, 8
    v_cvt_f32_i32 v217, v217
    v_bfe_i32 v218, v230, 16, 8
    v_cvt_f32_i32 v218, v218
    v_bfe_i32 v219, v230, 24, 8
    v_cvt_f32_i32 v219, v219
    s_waitcnt lgkmcnt(0)
    v_bfe_i32 v220, v231, 0, 8
    v_cvt_f32_i32 v220, v220
    v_bfe_i32 v221, v231, 8, 8
    v_cvt_f32_i32 v221, v221
    v_bfe_i32 v222, v231, 16, 8
    v_cvt_f32_i32 v222, v222
    v_bfe_i32 v223, v231, 24, 8
    v_cvt_f32_i32 v223, v223
    s_cmp_ge_u32 s28, 4
    s_cbranch_scc1 L_XP
    s_lshr_b32 s44, s2, 6
    s_cmp_lg_u32 s44, 0
    s_cbranch_scc1 L_PC1
    s_mov_b32 s56, 0x3f80
    s_mov_b32 s58, 0x4080
    s_mov_b32 s60, 0x4180
    s_mov_b32 s62, 0x3f80
    s_mov_b32 s98, 0x4080
    s_mov_b32 s100, 0x0
    v_mov_b32 v56, 0xbd03513b
    v_mov_b32 v57, 0xbd83513b
    v_mov_b32 v58, 0xbd03513b
    v_mov_b32 v59, 0x3d83513b
    s_branch L_PCD
L_PC1:
    s_cmp_lg_u32 s44, 1
    s_cbranch_scc1 L_PC2
    s_mov_b32 s56, 0x4180
    s_mov_b32 s58, 0x4080
    s_mov_b32 s60, 0x3f80
    s_mov_b32 s62, 0x4080
    s_mov_b32 s98, 0x3f80
    s_mov_b32 s100, 0x0
    v_mov_b32 v56, 0xbc03513b
    v_mov_b32 v57, 0xbc83513b
    v_mov_b32 v58, 0xbc03513b
    v_mov_b32 v59, 0x3c83513b
    s_branch L_PCD
L_PC2:
    s_cmp_lg_u32 s44, 2
    s_cbranch_scc1 L_PC3
    s_mov_b32 s56, 0x3f80
    s_mov_b32 s58, 0x3f80
    s_mov_b32 s60, 0x3f80
    s_mov_b32 s62, 0x3f80
    s_mov_b32 s98, 0x3f80
    s_mov_b32 s100, 0x0
    v_mov_b32 v56, 0x3ea4258a
    v_mov_b32 v57, 0x3ea4258a
    v_mov_b32 v58, 0x3ea4258a
    v_mov_b32 v59, 0xbea4258a
    s_branch L_PCD
L_PC3:
    s_mov_b32 s56, 0x3f80
    s_mov_b32 s58, 0x0
    s_mov_b32 s60, 0x0
    s_mov_b32 s62, 0x0
    s_mov_b32 s98, 0x0
    s_mov_b32 s100, 0x3f80
    v_mov_b32 v56, 0xbf76384f
    v_mov_b32 v57, 0x00000000
    v_mov_b32 v58, 0x00000000
    v_mov_b32 v59, 0xbef6384f
L_PCD:
    s_lshl_b32 s57, s56, 16
    s_lshl_b32 s59, s58, 16
    s_lshl_b32 s61, s60, 16
    s_lshl_b32 s63, s62, 16
    s_lshl_b32 s99, s98, 16
    s_lshl_b32 s101, s100, 16
    v_bfe_u32 v92, v251, 3, 2
    v_xor_b32 v92, s31, v92
    v_lshlrev_b32 v92, 5, v92
    v_lshrrev_b32 v93, 2, v251
    v_lshl_add_u32 v92, v93, 7, v92
    v_and_b32 v93, 3, v251
    v_lshl_add_u32 v92, v93, 3, v92
    v_add_u32 v92, 139264, v92
    s_lshl_b32 s45, s31, 2
    s_add_u32 s45, s45, 163584
    v_mov_b32 v93, s45
    v_mov_b32 v94, 163584
    s_lshr_b32 s48, s2, 7
    s_lshl_b32 s48, s48, 6
    s_and_b32 s49, s2, 0x38
    s_add_u32 s48, s48, s49
    s_bfe_u32 s49, s2, 0x10006
    s_lshl_b32 s49, s49, 2
    s_add_u32 s48, s48, s49
    s_bfe_u32 s49, s2, 0x10002
    s_add_u32 s48, s48, s49
    s_lshl_b32 s48, s48, 14
    s_and_b32 s49, s2, 3
    s_lshl_b32 s49, s49, 2
    s_add_u32 s49, s49, s31
    s_lshl_b32 s49, s49, 10
    s_add_u32 s48, s48, s49
    s_add_u32 s49, s48, 32768
    v_mov_b32 v60, 0
    v_mov_b32 v61, 0
    s_waitcnt vmcnt(1)
    ds_write_b128 v95, v[0:3] offset:0
    v_pk_maximum3_f16 v60, v60, v0, v0 neg_lo:[0,0,1] neg_hi:[0,0,1]
    v_pk_maximum3_f16 v61, v61, v1, v1 neg_lo:[0,0,1] neg_hi:[0,0,1]
    v_pk_maximum3_f16 v60, v60, v2, v2 neg_lo:[0,0,1] neg_hi:[0,0,1]
    v_pk_maximum3_f16 v61, v61, v3, v3 neg_lo:[0,0,1] neg_hi:[0,0,1]
    ds_write_b128 v95, v[4:7] offset:4096
    v_pk_maximum3_f16 v60, v60, v4, v4 neg_lo:[0,0,1] neg_hi:[0,0,1]
    v_pk_maximum3_f16 v61, v61, v5, v5 neg_lo:[0,0,1] neg_hi:[0,0,1]
    v_pk_maximum3_f16 v60, v60, v6, v6 neg_lo:[0,0,1] neg_hi:[0,0,1]
    v_pk_maximum3_f16 v61, v61, v7, v7 neg_lo:[0,0,1] neg_hi:[0,0,1]
    ds_write_b128 v95, v[8:11] offset:8192
    v_pk_maximum3_f16 v60, v60, v8, v8 neg_lo:[0,0,1] neg_hi:[0,0,1]
    v_pk_maximum3_f16 v61, v61, v9, v9 neg_lo:[0,0,1] neg_hi:[0,0,1]
    v_pk_maximum3_f16 v60, v60, v10, v10 neg_lo:[0,0,1] neg_hi:[0,0,1]
    v_pk_maximum3_f16 v61, v61, v11, v11 neg_lo:[0,0,1] neg_hi:[0,0,1]
    ds_write_b128 v95, v[12:15] offset:12288
    v_pk_maximum3_f16 v60, v60, v12, v12 neg_lo:[0,0,1] neg_hi:[0,0,1]
    v_pk_maximum3_f16 v61, v61, v13, v13 neg_lo:[0,0,1] neg_hi:[0,0,1]
    v_pk_maximum3_f16 v60, v60, v14, v14 neg_lo:[0,0,1] neg_hi:[0,0,1]
    v_pk_maximum3_f16 v61, v61, v15, v15 neg_lo:[0,0,1] neg_hi:[0,0,1]
    ds_write_b128 v95, v[16:19] offset:16384
    v_pk_maximum3_f16 v60, v60, v16, v16 neg_lo:[0,0,1] neg_hi:[0,0,1]
    v_pk_maximum3_f16 v61, v61, v17, v17 neg_lo:[0,0,1] neg_hi:[0,0,1]
    v_pk_maximum3_f16 v60, v60, v18, v18 neg_lo:[0,0,1] neg_hi:[0,0,1]
    v_pk_maximum3_f16 v61, v61, v19, v19 neg_lo:[0,0,1] neg_hi:[0,0,1]
    v_pk_max_u16 v60, v60, v61
    v_lshrrev_b32 v61, 16, v60
    v_and_b32 v60, 0xffff, v60
    v_max_u32 v60, v60, v61
    s_nop 1
    v_max_u32_dpp v60, v60, v60 row_shr:1 row_mask:0xf bank_mask:0xf bound_ctrl:0
    s_nop 1
    v_max_u32_dpp v60, v60, v60 row_shr:2 row_mask:0xf bank_mask:0xf bound_ctrl:0
    s_nop 1
    v_max_u32_dpp v60, v60, v60 row_shr:4 row_mask:0xf bank_mask:0xf bound_ctrl:0
    s_nop 1
    v_max_u32_dpp v60, v60, v60 row_shr:8 row_mask:0xf bank_mask:0xf bound_ctrl:0
    s_nop 1
    v_max_u32_dpp v60, v60, v60 row_bcast:15 row_mask:0xa bank_mask:0xf
    s_nop 1
    v_max_u32_dpp v60, v60, v60 row_bcast:31 row_mask:0xc bank_mask:0xf
    s_nop 0
    v_readlane_b32 s44, v60, 63
    s_or_b32 s44, s44, 0x80000000
    s_nop 0
    v_mov_b32 v60, s44
    ds_write_b32 v93, v60
    s_mov_b32 s47, 0
L_PSPIN:
    ds_read_b128 v[8:11], v94
    s_waitcnt lgkmcnt(0)
    v_and_b32 v12, v8, v9
    v_and_b32 v0, v10, v11
    v_and_b32 v12, v12, v0
    v_max_u32 v8, v8, v9
    v_max3_u32 v8, v8, v10, v11
    v_readfirstlane_b32 s44, v12
    v_readfirstlane_b32 s45, v8
    s_add_u32 s47, s47, 1
    s_cmp_gt_u32 s47, 100000
    s_cbranch_scc1 L_PGO
    s_bitcmp1_b32 s44, 31
    s_cbranch_scc0 L_PSPIN
L_PGO:
    ds_read_b64_tr_b16 v[36:37], v92 offset:16384
    ds_read_b64_tr_b16 v[38:39], v92 offset:18432
    ds_read_b64_tr_b16 v[28:29], v92 offset:8192
    ds_read_b64_tr_b16 v[30:31], v92 offset:10240
    ds_read_b64_tr_b16 v[20:21], v92 offset:0
    ds_read_b64_tr_b16 v[22:23], v92 offset:2048
    ds_read_b64_tr_b16 v[32:33], v92 offset:12288
    ds_read_b64_tr_b16 v[34:35], v92 offset:14336
    ds_read_b64_tr_b16 v[24:25], v92 offset:4096
    ds_read_b64_tr_b16 v[26:27], v92 offset:6144
    s_bfe_u32 s45, s45, 0x80007
    s_sub_i32 s45, 139, s45
    s_and_b32 s45, s45, -4
    s_max_i32 s45, s45, -40
    s_min_i32 s46, s45, 40
    s_bitcmp0_b32 s2, 2
    s_addc_u32 s45, s46, 127
    s_lshl_b32 s45, s45, 23
    v_mul_f32 v56, s45, v56
    v_mul_f32 v57, s45, v57
    v_mul_f32 v58, s45, v58
    v_mul_f32 v59, s45, v59
    s_waitcnt lgkmcnt(9)
    v_dot2_f32_bf16 v40, v36, s56, 0
    v_dot2_f32_bf16 v41, v36, s57, 0
    v_dot2_f32_bf16 v42, v37, s56, 0
    v_dot2_f32_bf16 v43, v37, s57, 0
    s_waitcnt lgkmcnt(8)
    v_dot2_f32_bf16 v44, v38, s56, 0
    v_dot2_f32_bf16 v45, v38, s57, 0
    v_dot2_f32_bf16 v46, v39, s56, 0
    v_dot2_f32_bf16 v47, v39, s57, 0
    s_waitcnt lgkmcnt(7)
    v_dot2_f32_bf16 v40, v28, s58, v40
    v_dot2_f32_bf16 v41, v28, s59, v41
    v_dot2_f32_bf16 v42, v29, s58, v42
    v_dot2_f32_bf16 v43, v29, s59, v43
    s_waitcnt lgkmcnt(6)
    v_dot2_f32_bf16 v44, v30, s58, v44
    v_dot2_f32_bf16 v45, v30, s59, v45
    v_dot2_f32_bf16 v46, v31, s58, v46
    v_dot2_f32_bf16 v47, v31, s59, v47
    s_waitcnt lgkmcnt(5)
    v_dot2_f32_bf16 v40, v20, s60, v40
    v_dot2_f32_bf16 v41, v20, s61, v41
    v_dot2_f32_bf16 v42, v21, s60, v42
    v_dot2_f32_bf16 v43, v21, s61, v43
    s_waitcnt lgkmcnt(4)
    v_dot2_f32_bf16 v44, v22, s60, v44
    v_dot2_f32_bf16 v45, v22, s61, v45
    v_dot2_f32_bf16 v46, v23, s60, v46
    v_dot2_f32_bf16 v47, v23, s61, v47
    v_dot2_f32_bf16 v48, v20, s100, 0
    v_dot2_f32_bf16 v49, v20, s101, 0
    v_dot2_f32_bf16 v50, v21, s100, 0
    v_dot2_f32_bf16 v51, v21, s101, 0
    v_dot2_f32_bf16 v52, v22, s100, 0
    v_dot2_f32_bf16 v53, v22, s101, 0
    v_dot2_f32_bf16 v54, v23, s100, 0
    v_dot2_f32_bf16 v55, v23, s101, 0
    s_waitcnt lgkmcnt(3)
    v_dot2_f32_bf16 v48, v32, s62, v48
    v_dot2_f32_bf16 v49, v32, s63, v49
    v_dot2_f32_bf16 v50, v33, s62, v50
    v_dot2_f32_bf16 v51, v33, s63, v51
    s_waitcnt lgkmcnt(2)
    v_dot2_f32_bf16 v52, v34, s62, v52
    v_dot2_f32_bf16 v53, v34, s63, v53
    v_dot2_f32_bf16 v54, v35, s62, v54
    v_dot2_f32_bf16 v55, v35, s63, v55
    s_waitcnt lgkmcnt(1)
    v_dot2_f32_bf16 v48, v24, s98, v48
    v_dot2_f32_bf16 v49, v24, s99, v49
    v_dot2_f32_bf16 v50, v25, s98, v50
    v_dot2_f32_bf16 v51, v25, s99, v51
    s_waitcnt lgkmcnt(0)
    v_dot2_f32_bf16 v52, v26, s98, v52
    v_dot2_f32_bf16 v53, v26, s99, v53
    v_dot2_f32_bf16 v54, v27, s98, v54
    v_dot2_f32_bf16 v55, v27, s99, v55
    v_pk_mul_f32 v[64:65], v[40:41], v[56:57] op_sel_hi:[1,0]
    v_pk_mul_f32 v[66:67], v[42:43], v[56:57] op_sel_hi:[1,0]
    v_pk_mul_f32 v[68:69], v[44:45], v[56:57] op_sel_hi:[1,0]
    v_pk_mul_f32 v[70:71], v[46:47], v[56:57] op_sel_hi:[1,0]
    v_pk_fma_f32 v[64:65], v[48:49], v[56:57], v[64:65] op_sel:[0,1,0]
    v_pk_fma_f32 v[66:67], v[50:51], v[56:57], v[66:67] op_sel:[0,1,0]
    v_pk_fma_f32 v[68:69], v[52:53], v[56:57], v[68:69] op_sel:[0,1,0]
    v_pk_fma_f32 v[70:71], v[54:55], v[56:57], v[70:71] op_sel:[0,1,0]
    v_cvt_pk_f16_f32 v0, v64, v65
    v_cvt_pk_f16_f32 v1, v66, v67
    v_cvt_pk_f16_f32 v2, v68, v69
    v_cvt_pk_f16_f32 v3, v70, v71
    buffer_store_dwordx4 v[0:3], v247, s[20:23], s48 offen sc1
    v_pk_mul_f32 v[72:73], v[40:41], v[58:59] op_sel_hi:[1,0]
    v_pk_mul_f32 v[74:75], v[42:43], v[58:59] op_sel_hi:[1,0]
    v_pk_mul_f32 v[76:77], v[44:45], v[58:59] op_sel_hi:[1,0]
    v_pk_mul_f32 v[78:79], v[46:47], v[58:59] op_sel_hi:[1,0]
    v_pk_fma_f32 v[72:73], v[48:49], v[58:59], v[72:73] op_sel:[0,1,0]
    v_pk_fma_f32 v[74:75], v[50:51], v[58:59], v[74:75] op_sel:[0,1,0]
    v_pk_fma_f32 v[76:77], v[52:53], v[58:59], v[76:77] op_sel:[0,1,0]
    v_pk_fma_f32 v[78:79], v[54:55], v[58:59], v[78:79] op_sel:[0,1,0]
    v_cvt_pk_f16_f32 v4, v72, v73
    v_cvt_pk_f16_f32 v5, v74, v75
    v_cvt_pk_f16_f32 v6, v76, v77
    v_cvt_pk_f16_f32 v7, v78, v79
    buffer_store_dwordx4 v[4:7], v247, s[20:23], s49 offen sc1
    s_cmp_lg_u32 s28, 0
    s_cbranch_scc1 L_PDONE
    s_cmp_ge_u32 s2, 64
    s_cbranch_scc1 L_PWO
    v_mov_b32 v12, s46
    s_and_b32 s44, s2, 7
    s_lshl_b32 s44, s44, 10
    s_and_b32 s45, s2, 0x38
    s_lshl_b32 s45, s45, 4
    s_add_u32 s44, s44, s45
    s_add_u32 s44, s44, 2097152
    v_mov_b32 v13, s44
    s_mov_b64 exec, 1
    buffer_store_dword v12, v13, s[20:23], 0 offen sc1
    s_mov_b64 exec, -1
L_PWO:
    s_lshr_b32 s44, s2, 6
    s_cmp_lg_u32 s44, 2
    s_cbranch_scc1 L_PDONE
    s_and_b32 s44, s2, 63
    s_lshr_b32 s45, s44, 1
    s_and_b32 s46, s44, 1
    v_lshlrev_b32 v9, 14, v249
    v_bfe_u32 v10, v248, 1, 1
    v_lshl_add_u32 v9, v10, 10, v9
    v_lshrrev_b32 v10, 2, v248
    v_lshl_add_u32 v9, v10, 6, v9
    v_and_b32 v10, 1, v248
    v_lshl_add_u32 v9, v10, 5, v9
    s_lshr_b32 s47, s45, 2
    s_and_b32 s48, s45, 3
    s_lshl_b32 s47, s47, 11
    s_lshl_b32 s48, s48, 8
    s_lshl_b32 s46, s46, 16
    s_add_u32 s47, s47, s48
    s_add_u32 s47, s47, s46
    s_add_u32 s47, s47, 2162688
    s_mov_b32 s49, 0x05040100
    s_mov_b32 s50, 0x07060302
    v_perm_b32 v24, v85, v84, s49
    v_perm_b32 v28, v85, v84, s50
    v_perm_b32 v25, v87, v86, s49
    v_perm_b32 v29, v87, v86, s50
    v_perm_b32 v26, v89, v88, s49
    v_perm_b32 v30, v89, v88, s50
    v_perm_b32 v27, v91, v90, s49
    v_perm_b32 v31, v91, v90, s50
    buffer_store_dwordx4 v[24:27], v9, s[20:23], s47 offen sc1
    buffer_store_dwordx4 v[28:31], v9, s[20:23], s47 offen offset:16 sc1
L_PDONE:
    s_barrier
    v_mov_b32 v13, 163600
    v_mov_b32 v12, 1
    s_bfe_u32 s45, s2, 0x10001
    s_lshl_b32 s46, s45, 6
    s_lshl_b32 s47, s45, 2
    s_add_u32 s47, s47, 128
    s_mov_b32 s49, 1
    s_mov_b32 s50, 1
    s_waitcnt vmcnt(0)
    s_cmp_ge_u32 s2, 128
    s_cbranch_scc1 L_PNF
    s_mov_b64 exec, 1
    ds_add_rtn_u32 v15, v13, v12
    s_waitcnt lgkmcnt(0)
    s_mov_b64 exec, -1
    v_readfirstlane_b32 s44, v15
    s_cmp_lg_u32 s44, 3
    s_cbranch_scc1 L_PNF
    s_atomic_add s49, s[24:25], s46 glc
    s_waitcnt lgkmcnt(0)
    s_cmp_lg_u32 s49, 63
    s_cbranch_scc1 L_PNF
    s_atomic_add s50, s[24:25], s47
L_PNF:
    s_setprio 0
    s_cmp_ge_u32 s30, 125
    s_cbranch_scc1 L_JOIN
    s_cmp_lg_u32 s28, 0
    s_cbranch_scc1 L_JOIN
    s_mov_b32 s44, 0
    s_mov_b64 exec, 1
L_UPOLL:
    buffer_load_dword v232, v252, s[24:27], 0 offen offset:128 sc1
    s_add_u32 s44, s44, 1
    s_waitcnt vmcnt(0)
    v_readfirstlane_b32 s45, v232
    s_cmp_lg_u32 s45, 0
    s_cbranch_scc1 L_UGO
    s_sleep 1
    s_cmp_lt_u32 s44, 100000
    s_cbranch_scc1 L_UPOLL
L_UGO:
    s_mov_b64 exec, -1
    s_branch L_JOIN
L_XP:
    v_mov_b32 v232, 0
    v_mov_b32 v233, 0
    s_barrier
    buffer_load_dwordx4 v[24:27], v203, s[4:7], s56 offen nt
    s_add_u32 s56, s56, 4096
    buffer_load_dwordx4 v[28:31], v203, s[4:7], s56 offen nt
    s_add_u32 s56, s56, 4096
    buffer_load_dwordx4 v[32:35], v203, s[4:7], s56 offen nt
    s_add_u32 s56, s56, 4096
    buffer_load_dwordx4 v[36:39], v203, s[4:7], s56 offen nt
    s_add_u32 s56, s56, 4096
    buffer_load_dwordx4 v[40:43], v203, s[4:7], s56 offen nt
    s_add_u32 s56, s56, 4096
    buffer_load_dwordx4 v[44:47], v203, s[4:7], s56 offen nt
    s_add_u32 s56, s56, 4096
    buffer_load_dwordx4 v[48:51], v203, s[4:7], s56 offen nt
    s_add_u32 s56, s56, 4096
    buffer_load_dwordx4 v[52:55], v203, s[4:7], s56 offen nt
    s_add_u32 s56, s56, 4096
    buffer_load_dwordx4 v[56:59], v203, s[4:7], s56 offen nt
    s_add_u32 s56, s56, 4096
    buffer_load_dwordx4 v[60:63], v203, s[4:7], s56 offen nt
    s_add_u32 s56, s56, 4096
    buffer_load_dwordx4 v[64:67], v203, s[4:7], s56 offen nt
    s_add_u32 s56, s56, 4096
    buffer_load_dwordx4 v[68:71], v208, s[4:7], 0 offen nt
    buffer_load_dwordx4 v[72:75], v203, s[4:7], s57 offen nt
    s_add_u32 s57, s57, 4096
    buffer_load_dwordx4 v[76:79], v203, s[4:7], s57 offen nt
    s_add_u32 s57, s57, 4096
    buffer_load_dwordx4 v[80:83], v203, s[4:7], s57 offen nt
    s_add_u32 s57, s57, 4096
    buffer_load_dwordx4 v[84:87], v203, s[4:7], s57 offen nt
    s_add_u32 s57, s57, 4096
    buffer_load_dwordx4 v[88:91], v203, s[4:7], s57 offen nt
    s_add_u32 s57, s57, 4096
    buffer_load_dwordx4 v[92:95], v203, s[4:7], s57 offen nt
    s_add_u32 s57, s57, 4096
    s_waitcnt vmcnt(23)
    buffer_load_dwordx4 v[96:99], v203, s[4:7], s57 offen nt
    s_add_u32 s57, s57, 4096
    ds_write_b128 v206, v[0:3] offset:0
    v_pk_maximum3_f16 v232, v232, v0, v0 neg_lo:[0,0,1] neg_hi:[0,0,1]
    v_pk_maximum3_f16 v233, v233, v1, v1 neg_lo:[0,0,1] neg_hi:[0,0,1]
    v_pk_maximum3_f16 v232, v232, v2, v2 neg_lo:[0,0,1] neg_hi:[0,0,1]
    v_pk_maximum3_f16 v233, v233, v3, v3 neg_lo:[0,0,1] neg_hi:[0,0,1]
    s_waitcnt vmcnt(23)
    buffer_load_dwordx4 v[100:103], v203, s[4:7], s57 offen nt
    s_add_u32 s57, s57, 4096
    ds_write_b128 v207, v[4:7] offset:512
    v_pk_maximum3_f16 v232, v232, v4, v4 neg_lo:[0,0,1] neg_hi:[0,0,1]
    v_pk_maximum3_f16 v233, v233, v5, v5 neg_lo:[0,0,1] neg_hi:[0,0,1]
    v_pk_maximum3_f16 v232, v232, v6, v6 neg_lo:[0,0,1] neg_hi:[0,0,1]
    v_pk_maximum3_f16 v233, v233, v7, v7 neg_lo:[0,0,1] neg_hi:[0,0,1]
    s_waitcnt vmcnt(23)
    buffer_load_dwordx4 v[104:107], v203, s[4:7], s57 offen nt
    s_add_u32 s57, s57, 4096
    ds_write_b128 v206, v[8:11] offset:1024
    v_pk_maximum3_f16 v232, v232, v8, v8 neg_lo:[0,0,1] neg_hi:[0,0,1]
    v_pk_maximum3_f16 v233, v233, v9, v9 neg_lo:[0,0,1] neg_hi:[0,0,1]
    v_pk_maximum3_f16 v232, v232, v10, v10 neg_lo:[0,0,1] neg_hi:[0,0,1]
    v_pk_maximum3_f16 v233, v233, v11, v11 neg_lo:[0,0,1] neg_hi:[0,0,1]
    s_waitcnt vmcnt(23)
    buffer_load_dwordx4 v[108:111], v203, s[4:7], s57 offen nt
    s_add_u32 s57, s57, 4096
    ds_write_b128 v207, v[12:15] offset:1536
    v_pk_maximum3_f16 v232, v232, v12, v12 neg_lo:[0,0,1] neg_hi:[0,0,1]
    v_pk_maximum3_f16 v233, v233, v13, v13 neg_lo:[0,0,1] neg_hi:[0,0,1]
    v_pk_maximum3_f16 v232, v232, v14, v14 neg_lo:[0,0,1] neg_hi:[0,0,1]
    v_pk_maximum3_f16 v233, v233, v15, v15 neg_lo:[0,0,1] neg_hi:[0,0,1]
    s_waitcnt vmcnt(23)
    buffer_load_dwordx4 v[112:115], v203, s[4:7], s57 offen nt
    s_add_u32 s57, s57, 4096
    ds_write_b128 v206, v[16:19] offset:2048
    v_pk_maximum3_f16 v232, v232, v16, v16 neg_lo:[0,0,1] neg_hi:[0,0,1]
    v_pk_maximum3_f16 v233, v233, v17, v17 neg_lo:[0,0,1] neg_hi:[0,0,1]
    v_pk_maximum3_f16 v232, v232, v18, v18 neg_lo:[0,0,1] neg_hi:[0,0,1]
    v_pk_maximum3_f16 v233, v233, v19, v19 neg_lo:[0,0,1] neg_hi:[0,0,1]
    s_waitcnt vmcnt(23)
    buffer_load_dwordx4 v[116:119], v203, s[4:7], s57 offen nt
    s_add_u32 s57, s57, 4096
    ds_write_b128 v207, v[20:23] offset:2560
    v_pk_maximum3_f16 v232, v232, v20, v20 neg_lo:[0,0,1] neg_hi:[0,0,1]
    v_pk_maximum3_f16 v233, v233, v21, v21 neg_lo:[0,0,1] neg_hi:[0,0,1]
    v_pk_maximum3_f16 v232, v232, v22, v22 neg_lo:[0,0,1] neg_hi:[0,0,1]
    v_pk_maximum3_f16 v233, v233, v23, v23 neg_lo:[0,0,1] neg_hi:[0,0,1]
    s_waitcnt vmcnt(23)
    buffer_load_dwordx4 v[120:123], v203, s[4:7], s57 offen nt
    s_add_u32 s57, s57, 4096
    ds_write_b128 v206, v[24:27] offset:3072
    v_pk_maximum3_f16 v232, v232, v24, v24 neg_lo:[0,0,1] neg_hi:[0,0,1]
    v_pk_maximum3_f16 v233, v233, v25, v25 neg_lo:[0,0,1] neg_hi:[0,0,1]
    v_pk_maximum3_f16 v232, v232, v26, v26 neg_lo:[0,0,1] neg_hi:[0,0,1]
    v_pk_maximum3_f16 v233, v233, v27, v27 neg_lo:[0,0,1] neg_hi:[0,0,1]
    s_waitcnt vmcnt(23)
    buffer_load_dwordx4 v[124:127], v203, s[4:7], s57 offen nt
    s_add_u32 s57, s57, 4096
    ds_write_b128 v207, v[28:31] offset:3584
    v_pk_maximum3_f16 v232, v232, v28, v28 neg_lo:[0,0,1] neg_hi:[0,0,1]
    v_pk_maximum3_f16 v233, v233, v29, v29 neg_lo:[0,0,1] neg_hi:[0,0,1]
    v_pk_maximum3_f16 v232, v232, v30, v30 neg_lo:[0,0,1] neg_hi:[0,0,1]
    v_pk_maximum3_f16 v233, v233, v31, v31 neg_lo:[0,0,1] neg_hi:[0,0,1]
    s_waitcnt vmcnt(23)
    buffer_load_dwordx4 v[128:131], v203, s[4:7], s57 offen nt
    s_add_u32 s57, s57, 4096
    ds_write_b128 v206, v[32:35] offset:4096
    v_pk_maximum3_f16 v232, v232, v32, v32 neg_lo:[0,0,1] neg_hi:[0,0,1]
    v_pk_maximum3_f16 v233, v233, v33, v33 neg_lo:[0,0,1] neg_hi:[0,0,1]
    v_pk_maximum3_f16 v232, v232, v34, v34 neg_lo:[0,0,1] neg_hi:[0,0,1]
    v_pk_maximum3_f16 v233, v233, v35, v35 neg_lo:[0,0,1] neg_hi:[0,0,1]
    s_waitcnt vmcnt(23)
    buffer_load_dwordx4 v[132:135], v203, s[4:7], s57 offen nt
    s_add_u32 s57, s57, 4096
    ds_write_b128 v207, v[36:39] offset:4608
    v_pk_maximum3_f16 v232, v232, v36, v36 neg_lo:[0,0,1] neg_hi:[0,0,1]
    v_pk_maximum3_f16 v233, v233, v37, v37 neg_lo:[0,0,1] neg_hi:[0,0,1]
    v_pk_maximum3_f16 v232, v232, v38, v38 neg_lo:[0,0,1] neg_hi:[0,0,1]
    v_pk_maximum3_f16 v233, v233, v39, v39 neg_lo:[0,0,1] neg_hi:[0,0,1]
    s_waitcnt vmcnt(23)
    ds_write_b128 v206, v[40:43] offset:5120
    v_pk_maximum3_f16 v232, v232, v40, v40 neg_lo:[0,0,1] neg_hi:[0,0,1]
    v_pk_maximum3_f16 v233, v233, v41, v41 neg_lo:[0,0,1] neg_hi:[0,0,1]
    v_pk_maximum3_f16 v232, v232, v42, v42 neg_lo:[0,0,1] neg_hi:[0,0,1]
    v_pk_maximum3_f16 v233, v233, v43, v43 neg_lo:[0,0,1] neg_hi:[0,0,1]
    s_waitcnt vmcnt(22)
    ds_write_b128 v207, v[44:47] offset:5632
    v_pk_maximum3_f16 v232, v232, v44, v44 neg_lo:[0,0,1] neg_hi:[0,0,1]
    v_pk_maximum3_f16 v233, v233, v45, v45 neg_lo:[0,0,1] neg_hi:[0,0,1]
    v_pk_maximum3_f16 v232, v232, v46, v46 neg_lo:[0,0,1] neg_hi:[0,0,1]
    v_pk_maximum3_f16 v233, v233, v47, v47 neg_lo:[0,0,1] neg_hi:[0,0,1]
    s_waitcnt vmcnt(21)
    ds_write_b128 v206, v[48:51] offset:6144
    v_pk_maximum3_f16 v232, v232, v48, v48 neg_lo:[0,0,1] neg_hi:[0,0,1]
    v_pk_maximum3_f16 v233, v233, v49, v49 neg_lo:[0,0,1] neg_hi:[0,0,1]
    v_pk_maximum3_f16 v232, v232, v50, v50 neg_lo:[0,0,1] neg_hi:[0,0,1]
    v_pk_maximum3_f16 v233, v233, v51, v51 neg_lo:[0,0,1] neg_hi:[0,0,1]
    s_waitcnt vmcnt(20)
    ds_write_b128 v207, v[52:55] offset:6656
    v_pk_maximum3_f16 v232, v232, v52, v52 neg_lo:[0,0,1] neg_hi:[0,0,1]
    v_pk_maximum3_f16 v233, v233, v53, v53 neg_lo:[0,0,1] neg_hi:[0,0,1]
    v_pk_maximum3_f16 v232, v232, v54, v54 neg_lo:[0,0,1] neg_hi:[0,0,1]
    v_pk_maximum3_f16 v233, v233, v55, v55 neg_lo:[0,0,1] neg_hi:[0,0,1]
    s_waitcnt vmcnt(19)
    ds_write_b128 v206, v[56:59] offset:7168
    v_pk_maximum3_f16 v232, v232, v56, v56 neg_lo:[0,0,1] neg_hi:[0,0,1]
    v_pk_maximum3_f16 v233, v233, v57, v57 neg_lo:[0,0,1] neg_hi:[0,0,1]
    v_pk_maximum3_f16 v232, v232, v58, v58 neg_lo:[0,0,1] neg_hi:[0,0,1]
    v_pk_maximum3_f16 v233, v233, v59, v59 neg_lo:[0,0,1] neg_hi:[0,0,1]
    s_waitcnt vmcnt(18)
    ds_write_b128 v207, v[60:63] offset:7680
    v_pk_maximum3_f16 v232, v232, v60, v60 neg_lo:[0,0,1] neg_hi:[0,0,1]
    v_pk_maximum3_f16 v233, v233, v61, v61 neg_lo:[0,0,1] neg_hi:[0,0,1]
    v_pk_maximum3_f16 v232, v232, v62, v62 neg_lo:[0,0,1] neg_hi:[0,0,1]
    v_pk_maximum3_f16 v233, v233, v63, v63 neg_lo:[0,0,1] neg_hi:[0,0,1]
    s_waitcnt vmcnt(17)
    ds_write_b128 v206, v[64:67] offset:8192
    v_pk_maximum3_f16 v232, v232, v64, v64 neg_lo:[0,0,1] neg_hi:[0,0,1]
    v_pk_maximum3_f16 v233, v233, v65, v65 neg_lo:[0,0,1] neg_hi:[0,0,1]
    v_pk_maximum3_f16 v232, v232, v66, v66 neg_lo:[0,0,1] neg_hi:[0,0,1]
    v_pk_maximum3_f16 v233, v233, v67, v67 neg_lo:[0,0,1] neg_hi:[0,0,1]
    s_waitcnt vmcnt(16)
    s_cmp_eq_u32 s29, 0
    s_cselect_b32 s47, -1, 1
    s_mul_i32 s47, s47, 8704
    v_add_u32 v206, s47, v206
    v_add_u32 v207, s47, v207
    ds_write_b128 v206, v[68:71] offset:0
    v_pk_maximum3_f16 v232, v232, v68, v68 neg_lo:[0,0,1] neg_hi:[0,0,1]
    v_pk_maximum3_f16 v233, v233, v69, v69 neg_lo:[0,0,1] neg_hi:[0,0,1]
    v_pk_maximum3_f16 v232, v232, v70, v70 neg_lo:[0,0,1] neg_hi:[0,0,1]
    v_pk_maximum3_f16 v233, v233, v71, v71 neg_lo:[0,0,1] neg_hi:[0,0,1]
    s_waitcnt vmcnt(15)
    ds_write_b128 v207, v[72:75] offset:512
    v_pk_maximum3_f16 v232, v232, v72, v72 neg_lo:[0,0,1] neg_hi:[0,0,1]
    v_pk_maximum3_f16 v233, v233, v73, v73 neg_lo:[0,0,1] neg_hi:[0,0,1]
    v_pk_maximum3_f16 v232, v232, v74, v74 neg_lo:[0,0,1] neg_hi:[0,0,1]
    v_pk_maximum3_f16 v233, v233, v75, v75 neg_lo:[0,0,1] neg_hi:[0,0,1]
    s_waitcnt vmcnt(14)
    ds_write_b128 v206, v[76:79] offset:1024
    v_pk_maximum3_f16 v232, v232, v76, v76 neg_lo:[0,0,1] neg_hi:[0,0,1]
    v_pk_maximum3_f16 v233, v233, v77, v77 neg_lo:[0,0,1] neg_hi:[0,0,1]
    v_pk_maximum3_f16 v232, v232, v78, v78 neg_lo:[0,0,1] neg_hi:[0,0,1]
    v_pk_maximum3_f16 v233, v233, v79, v79 neg_lo:[0,0,1] neg_hi:[0,0,1]
    s_waitcnt vmcnt(13)
    ds_write_b128 v207, v[80:83] offset:1536
    v_pk_maximum3_f16 v232, v232, v80, v80 neg_lo:[0,0,1] neg_hi:[0,0,1]
    v_pk_maximum3_f16 v233, v233, v81, v81 neg_lo:[0,0,1] neg_hi:[0,0,1]
    v_pk_maximum3_f16 v232, v232, v82, v82 neg_lo:[0,0,1] neg_hi:[0,0,1]
    v_pk_maximum3_f16 v233, v233, v83, v83 neg_lo:[0,0,1] neg_hi:[0,0,1]
    s_waitcnt vmcnt(12)
    ds_write_b128 v206, v[84:87] offset:2048
    v_pk_maximum3_f16 v232, v232, v84, v84 neg_lo:[0,0,1] neg_hi:[0,0,1]
    v_pk_maximum3_f16 v233, v233, v85, v85 neg_lo:[0,0,1] neg_hi:[0,0,1]
    v_pk_maximum3_f16 v232, v232, v86, v86 neg_lo:[0,0,1] neg_hi:[0,0,1]
    v_pk_maximum3_f16 v233, v233, v87, v87 neg_lo:[0,0,1] neg_hi:[0,0,1]
    s_waitcnt vmcnt(11)
    ds_write_b128 v207, v[88:91] offset:2560
    v_pk_maximum3_f16 v232, v232, v88, v88 neg_lo:[0,0,1] neg_hi:[0,0,1]
    v_pk_maximum3_f16 v233, v233, v89, v89 neg_lo:[0,0,1] neg_hi:[0,0,1]
    v_pk_maximum3_f16 v232, v232, v90, v90 neg_lo:[0,0,1] neg_hi:[0,0,1]
    v_pk_maximum3_f16 v233, v233, v91, v91 neg_lo:[0,0,1] neg_hi:[0,0,1]
    s_waitcnt vmcnt(10)
    ds_write_b128 v206, v[92:95] offset:3072
    v_pk_maximum3_f16 v232, v232, v92, v92 neg_lo:[0,0,1] neg_hi:[0,0,1]
    v_pk_maximum3_f16 v233, v233, v93, v93 neg_lo:[0,0,1] neg_hi:[0,0,1]
    v_pk_maximum3_f16 v232, v232, v94, v94 neg_lo:[0,0,1] neg_hi:[0,0,1]
    v_pk_maximum3_f16 v233, v233, v95, v95 neg_lo:[0,0,1] neg_hi:[0,0,1]
    s_waitcnt vmcnt(9)
    ds_write_b128 v207, v[96:99] offset:3584
    v_pk_maximum3_f16 v232, v232, v96, v96 neg_lo:[0,0,1] neg_hi:[0,0,1]
    v_pk_maximum3_f16 v233, v233, v97, v97 neg_lo:[0,0,1] neg_hi:[0,0,1]
    v_pk_maximum3_f16 v232, v232, v98, v98 neg_lo:[0,0,1] neg_hi:[0,0,1]
    v_pk_maximum3_f16 v233, v233, v99, v99 neg_lo:[0,0,1] neg_hi:[0,0,1]
    s_waitcnt vmcnt(8)
    ds_write_b128 v206, v[100:103] offset:4096
    v_pk_maximum3_f16 v232, v232, v100, v100 neg_lo:[0,0,1] neg_hi:[0,0,1]
    v_pk_maximum3_f16 v233, v233, v101, v101 neg_lo:[0,0,1] neg_hi:[0,0,1]
    v_pk_maximum3_f16 v232, v232, v102, v102 neg_lo:[0,0,1] neg_hi:[0,0,1]
    v_pk_maximum3_f16 v233, v233, v103, v103 neg_lo:[0,0,1] neg_hi:[0,0,1]
    s_waitcnt vmcnt(7)
    ds_write_b128 v207, v[104:107] offset:4608
    v_pk_maximum3_f16 v232, v232, v104, v104 neg_lo:[0,0,1] neg_hi:[0,0,1]
    v_pk_maximum3_f16 v233, v233, v105, v105 neg_lo:[0,0,1] neg_hi:[0,0,1]
    v_pk_maximum3_f16 v232, v232, v106, v106 neg_lo:[0,0,1] neg_hi:[0,0,1]
    v_pk_maximum3_f16 v233, v233, v107, v107 neg_lo:[0,0,1] neg_hi:[0,0,1]
    s_waitcnt vmcnt(6)
    ds_write_b128 v206, v[108:111] offset:5120
    v_pk_maximum3_f16 v232, v232, v108, v108 neg_lo:[0,0,1] neg_hi:[0,0,1]
    v_pk_maximum3_f16 v233, v233, v109, v109 neg_lo:[0,0,1] neg_hi:[0,0,1]
    v_pk_maximum3_f16 v232, v232, v110, v110 neg_lo:[0,0,1] neg_hi:[0,0,1]
    v_pk_maximum3_f16 v233, v233, v111, v111 neg_lo:[0,0,1] neg_hi:[0,0,1]
    s_waitcnt vmcnt(5)
    ds_write_b128 v207, v[112:115] offset:5632
    v_pk_maximum3_f16 v232, v232, v112, v112 neg_lo:[0,0,1] neg_hi:[0,0,1]
    v_pk_maximum3_f16 v233, v233, v113, v113 neg_lo:[0,0,1] neg_hi:[0,0,1]
    v_pk_maximum3_f16 v232, v232, v114, v114 neg_lo:[0,0,1] neg_hi:[0,0,1]
    v_pk_maximum3_f16 v233, v233, v115, v115 neg_lo:[0,0,1] neg_hi:[0,0,1]
    s_waitcnt vmcnt(4)
    ds_write_b128 v206, v[116:119] offset:6144
    v_pk_maximum3_f16 v232, v232, v116, v116 neg_lo:[0,0,1] neg_hi:[0,0,1]
    v_pk_maximum3_f16 v233, v233, v117, v117 neg_lo:[0,0,1] neg_hi:[0,0,1]
    v_pk_maximum3_f16 v232, v232, v118, v118 neg_lo:[0,0,1] neg_hi:[0,0,1]
    v_pk_maximum3_f16 v233, v233, v119, v119 neg_lo:[0,0,1] neg_hi:[0,0,1]
    s_waitcnt vmcnt(3)
    ds_write_b128 v207, v[120:123] offset:6656
    v_pk_maximum3_f16 v232, v232, v120, v120 neg_lo:[0,0,1] neg_hi:[0,0,1]
    v_pk_maximum3_f16 v233, v233, v121, v121 neg_lo:[0,0,1] neg_hi:[0,0,1]
    v_pk_maximum3_f16 v232, v232, v122, v122 neg_lo:[0,0,1] neg_hi:[0,0,1]
    v_pk_maximum3_f16 v233, v233, v123, v123 neg_lo:[0,0,1] neg_hi:[0,0,1]
    s_waitcnt vmcnt(2)
    ds_write_b128 v206, v[124:127] offset:7168
    v_pk_maximum3_f16 v232, v232, v124, v124 neg_lo:[0,0,1] neg_hi:[0,0,1]
    v_pk_maximum3_f16 v233, v233, v125, v125 neg_lo:[0,0,1] neg_hi:[0,0,1]
    v_pk_maximum3_f16 v232, v232, v126, v126 neg_lo:[0,0,1] neg_hi:[0,0,1]
    v_pk_maximum3_f16 v233, v233, v127, v127 neg_lo:[0,0,1] neg_hi:[0,0,1]
    s_waitcnt vmcnt(1)
    ds_write_b128 v207, v[128:131] offset:7680
    v_pk_maximum3_f16 v232, v232, v128, v128 neg_lo:[0,0,1] neg_hi:[0,0,1]
    v_pk_maximum3_f16 v233, v233, v129, v129 neg_lo:[0,0,1] neg_hi:[0,0,1]
    v_pk_maximum3_f16 v232, v232, v130, v130 neg_lo:[0,0,1] neg_hi:[0,0,1]
    v_pk_maximum3_f16 v233, v233, v131, v131 neg_lo:[0,0,1] neg_hi:[0,0,1]
    s_waitcnt vmcnt(0)
    ds_write_b128 v206, v[132:135] offset:8192
    v_pk_maximum3_f16 v232, v232, v132, v132 neg_lo:[0,0,1] neg_hi:[0,0,1]
    v_pk_maximum3_f16 v233, v233, v133, v133 neg_lo:[0,0,1] neg_hi:[0,0,1]
    v_pk_maximum3_f16 v232, v232, v134, v134 neg_lo:[0,0,1] neg_hi:[0,0,1]
    v_pk_maximum3_f16 v233, v233, v135, v135 neg_lo:[0,0,1] neg_hi:[0,0,1]
    v_pk_max_u16 v232, v232, v233
    v_lshrrev_b32 v233, 16, v232
    v_and_b32 v232, 0xffff, v232
    v_max_u32 v232, v232, v233
    s_nop 1
    v_max_u32_dpp v232, v232, v232 row_shr:1 row_mask:0xf bank_mask:0xf bound_ctrl:0
    s_nop 1
    v_max_u32_dpp v232, v232, v232 row_shr:2 row_mask:0xf bank_mask:0xf bound_ctrl:0
    s_nop 1
    v_max_u32_dpp v232, v232, v232 row_shr:4 row_mask:0xf bank_mask:0xf bound_ctrl:0
    s_nop 1
    v_max_u32_dpp v232, v232, v232 row_shr:8 row_mask:0xf bank_mask:0xf bound_ctrl:0
    s_nop 1
    v_max_u32_dpp v232, v232, v232 row_bcast:15 row_mask:0xa bank_mask:0xf
    s_nop 1
    v_max_u32_dpp v232, v232, v232 row_bcast:31 row_mask:0xc bank_mask:0xf
    s_nop 0
    v_readlane_b32 s44, v232, 63
    s_lshl_b32 s45, s31, 2
    s_add_u32 s45, s45, 163616
    v_mov_b32 v232, s44
    v_mov_b32 v233, s45
    ds_write_b32 v233, v232
L_JOIN:
    v_mov_b32 v235, 163616
    v_mov_b32 v252, 0
    v_mov_b32 v234, 32
    s_waitcnt lgkmcnt(0)
    s_barrier
    s_lshr_b32 s44, s2, 7
    s_sub_u32 s44, s44, s28
    s_cmp_lg_u32 s44, 1
    s_cbranch_scc1 L_NOA1
    v_mov_b32 v252, 1
    s_mov_b64 exec, 1
    buffer_atomic_add v252, v234, s[24:27], 0 offen sc0 sc1
    s_mov_b64 exec, -1
L_NOA1:
    s_cmp_lt_u32 s30, 125
    s_cbranch_scc1 L_WORK
    s_waitcnt vmcnt(0)
    v_readfirstlane_b32 s44, v252
    s_cmp_lg_u32 s44, 127
    s_cbranch_scc1 L_END
    v_mov_b32 v250, 136
    s_mov_b64 exec, 1
    buffer_store_dword v252, v250, s[24:27], 0 offen sc1
    s_mov_b64 exec, -1
    s_endpgm
L_WORK:
    ds_read_b128 v[0:3], v235
    ds_read_b64_tr_b16 v[48:49], v242 offset:0
    ds_read_b64_tr_b16 v[50:51], v242 offset:256
    ds_read_b64_tr_b16 v[52:53], v243 offset:0
    ds_read_b64_tr_b16 v[54:55], v243 offset:256
    ds_read_b64_tr_b16 v[208:209], v242 offset:8704
    ds_read_b64_tr_b16 v[210:211], v242 offset:8960
    ds_read_b64_tr_b16 v[212:213], v243 offset:8704
    ds_read_b64_tr_b16 v[214:215], v243 offset:8960
    s_mov_b32 s63, 0
    buffer_load_dwordx4 v[128:131], v246, s[20:23], s63 offen sc1
    s_mov_b32 s41, 16384
    buffer_load_dwordx4 v[132:135], v246, s[20:23], s41 offen sc1
    s_waitcnt lgkmcnt(8)
    v_max_u32 v0, v0, v1
    v_max3_u32 v0, v0, v2, v3
    s_nop 0
    v_readfirstlane_b32 s45, v0
    s_bfe_u32 s45, s45, 0x80007
    s_sub_i32 s54, 137, s45
    s_max_i32 s54, s54, -60
    s_min_i32 s54, s54, 60
    s_add_i32 s45, s54, 125
    s_lshl_b32 s55, s45, 23
    v_mul_f32 v216, s55, v216
    v_mul_f32 v217, s55, v217
    v_mul_f32 v218, s55, v218
    v_mul_f32 v219, s55, v219
    v_mul_f32 v220, s55, v220
    v_mul_f32 v221, s55, v221
    v_mul_f32 v222, s55, v222
    v_mul_f32 v223, s55, v223
    v_lshrrev_b32 v216, v239, v216
    v_lshrrev_b32 v217, v239, v217
    v_lshrrev_b32 v218, v239, v218
    v_lshrrev_b32 v219, v239, v219
    v_lshrrev_b32 v220, v239, v220
    v_lshrrev_b32 v221, v239, v221
    v_lshrrev_b32 v222, v239, v222
    v_lshrrev_b32 v223, v239, v223
    s_waitcnt lgkmcnt(4)
    v_mfma_f32_16x16x32_bf16 v[16:19], v[48:51], v[216:219], 0
    v_mfma_f32_16x16x32_bf16 v[20:23], v[52:55], v[216:219], 0
    v_mfma_f32_16x16x32_bf16 v[24:27], v[48:51], v[220:223], 0
    v_mfma_f32_16x16x32_bf16 v[28:31], v[52:55], v[220:223], 0
    s_mov_b32 s63, 32768
    buffer_load_dwordx4 v[136:139], v246, s[20:23], s63 offen sc1
    s_mov_b32 s41, 49152
    buffer_load_dwordx4 v[140:143], v246, s[20:23], s41 offen sc1
    s_waitcnt lgkmcnt(0)
    v_mfma_f32_16x16x32_bf16 v[224:227], v[208:211], v[216:219], 0
    v_mfma_f32_16x16x32_bf16 v[228:231], v[212:215], v[216:219], 0
    v_mfma_f32_16x16x32_bf16 v[232:235], v[208:211], v[220:223], 0
    v_mfma_f32_16x16x32_bf16 v[236:239], v[212:215], v[220:223], 0
    ds_read_b64_tr_b16 v[208:209], v242 offset:17408
    ds_read_b64_tr_b16 v[210:211], v242 offset:17664
    ds_read_b64_tr_b16 v[212:213], v243 offset:17408
    ds_read_b64_tr_b16 v[214:215], v243 offset:17664
    v_cvt_pk_f16_f32 v16, v16, v17
    v_cvt_pk_f16_f32 v17, v18, v19
    v_cvt_pk_f16_f32 v18, v20, v21
    v_cvt_pk_f16_f32 v19, v22, v23
    ds_write_b128 v244, v[16:19] offset:0
    s_mov_b32 s63, 65536
    buffer_load_dwordx4 v[144:147], v246, s[20:23], s63 offen sc1
    s_mov_b32 s41, 81920
    buffer_load_dwordx4 v[148:151], v246, s[20:23], s41 offen sc1
    v_cvt_pk_f16_f32 v224, v224, v225
    v_cvt_pk_f16_f32 v225, v226, v227
    v_cvt_pk_f16_f32 v226, v228, v229
    v_cvt_pk_f16_f32 v227, v230, v231
    ds_write_b128 v244, v[224:227] offset:8192
    s_mov_b32 s63, 98304
    buffer_load_dwordx4 v[152:155], v246, s[20:23], s63 offen sc1
    s_mov_b32 s41, 114688
    buffer_load_dwordx4 v[156:159], v246, s[20:23], s41 offen sc1
    buffer_load_dword v254, v254, s[20:23], 0 offen sc1
    buffer_load_dword v255, v255, s[20:23], 0 offen sc1
    v_cvt_pk_f16_f32 v24, v24, v25
    v_cvt_pk_f16_f32 v25, v26, v27
    v_cvt_pk_f16_f32 v26, v28, v29
    v_cvt_pk_f16_f32 v27, v30, v31
    v_cvt_pk_f16_f32 v232, v232, v233
    v_cvt_pk_f16_f32 v233, v234, v235
    v_cvt_pk_f16_f32 v234, v236, v237
    v_cvt_pk_f16_f32 v235, v238, v239
    s_sub_i32 s55, 127, s54
    s_waitcnt lgkmcnt(0)
    s_barrier
    ds_read_b128 v[192:195], v240 offset:0
    ds_read_b128 v[196:199], v240 offset:1024
    ds_read_b128 v[200:203], v241 offset:2048
    ds_read_b128 v[204:207], v241 offset:3072
    ds_write_b128 v245, v[24:27] offset:0
    ds_write_b128 v245, v[232:235] offset:8704
    s_waitcnt lgkmcnt(5)
    s_waitcnt vmcnt(9)
    v_mfma_f32_16x16x32_f16 v[0:3], v[128:131], v[192:195], 0
    s_waitcnt vmcnt(8)
    v_mfma_f32_16x16x32_f16 v[4:7], v[132:135], v[192:195], 0
    ds_read_b128 v[192:195], v240 offset:4096
    s_mov_b32 s63, 131072
    buffer_load_dwordx4 v[160:163], v246, s[20:23], s63 offen sc1
    v_mfma_f32_16x16x32_bf16 v[224:227], v[208:211], v[216:219], 0
    v_mfma_f32_16x16x32_bf16 v[232:235], v[208:211], v[220:223], 0
    ds_read_b64_tr_b16 v[208:209], v242 offset:26112
    v_mfma_f32_16x16x32_bf16 v[228:231], v[212:215], v[216:219], 0
    ds_read_b64_tr_b16 v[210:211], v242 offset:26368
    v_mfma_f32_16x16x32_bf16 v[236:239], v[212:215], v[220:223], 0
    ds_read_b64_tr_b16 v[212:213], v243 offset:26112
    s_waitcnt lgkmcnt(8)
    v_mfma_f32_16x16x32_f16 v[8:11], v[128:131], v[196:199], 0
    ds_read_b64_tr_b16 v[214:215], v243 offset:26368
    v_mfma_f32_16x16x32_f16 v[12:15], v[132:135], v[196:199], 0
    ds_read_b128 v[196:199], v240 offset:5120
    s_mov_b32 s41, 147456
    buffer_load_dwordx4 v[164:167], v246, s[20:23], s41 offen sc1
    s_waitcnt lgkmcnt(9)
    s_waitcnt vmcnt(9)
    v_mfma_f32_16x16x32_f16 v[32:35], v[136:139], v[200:203], 0
    v_cvt_pk_f16_f32 v224, v224, v225
    v_cvt_pk_f16_f32 v225, v226, v227
    s_waitcnt vmcnt(8)
    v_mfma_f32_16x16x32_f16 v[36:39], v[140:143], v[200:203], 0
    ds_read_b128 v[200:203], v241 offset:6144
    s_mov_b32 s63, 163840
    buffer_load_dwordx4 v[168:171], v246, s[20:23], s63 offen sc1
    v_cvt_pk_f16_f32 v226, v228, v229
    s_waitcnt lgkmcnt(9)
    v_mfma_f32_16x16x32_f16 v[40:43], v[136:139], v[204:207], 0
    v_cvt_pk_f16_f32 v227, v230, v231
    ds_write_b128 v244, v[224:227] offset:16384
    v_mfma_f32_16x16x32_f16 v[44:47], v[140:143], v[204:207], 0
    ds_read_b128 v[204:207], v241 offset:7168
    s_mov_b32 s41, 180224
    buffer_load_dwordx4 v[172:175], v246, s[20:23], s41 offen sc1
    s_waitcnt lgkmcnt(8)
    s_waitcnt vmcnt(9)
    v_mfma_f32_16x16x32_f16 v[64:67], v[144:147], v[192:195], 0
    v_cvt_pk_f16_f32 v232, v232, v233
    v_cvt_pk_f16_f32 v233, v234, v235
    s_waitcnt vmcnt(8)
    v_mfma_f32_16x16x32_f16 v[68:71], v[148:151], v[192:195], 0
    ds_read_b128 v[192:195], v240 offset:8192
    s_mov_b32 s63, 196608
    buffer_load_dwordx4 v[176:179], v246, s[20:23], s63 offen sc1
    v_cvt_pk_f16_f32 v234, v236, v237
    s_waitcnt lgkmcnt(4)
    v_mfma_f32_16x16x32_f16 v[72:75], v[144:147], v[196:199], 0
    v_cvt_pk_f16_f32 v235, v238, v239
    ds_write_b128 v245, v[232:235] offset:17408
    v_mfma_f32_16x16x32_f16 v[76:79], v[148:151], v[196:199], 0
    ds_read_b128 v[196:199], v240 offset:9216
    s_mov_b32 s41, 212992
    buffer_load_dwordx4 v[180:183], v246, s[20:23], s41 offen sc1
    s_waitcnt lgkmcnt(5)
    s_waitcnt vmcnt(9)
    v_mfma_f32_16x16x32_f16 v[96:99], v[152:155], v[200:203], 0
    s_waitcnt vmcnt(8)
    v_mfma_f32_16x16x32_f16 v[100:103], v[156:159], v[200:203], 0
    ds_read_b128 v[200:203], v241 offset:10240
    s_mov_b32 s63, 229376
    buffer_load_dwordx4 v[184:187], v246, s[20:23], s63 offen sc1
    s_waitcnt lgkmcnt(4)
    v_mfma_f32_16x16x32_f16 v[104:107], v[152:155], v[204:207], 0
    v_mfma_f32_16x16x32_f16 v[108:111], v[156:159], v[204:207], 0
    ds_read_b128 v[204:207], v241 offset:11264
    s_mov_b32 s41, 245760
    buffer_load_dwordx4 v[188:191], v246, s[20:23], s41 offen sc1
    s_waitcnt lgkmcnt(3)
    s_barrier
    v_readfirstlane_b32 s44, v252
    s_cmp_lg_u32 s44, 127
    s_cbranch_scc1 L_NG1
    v_mov_b32 v250, 136
    s_mov_b64 exec, 1
    buffer_store_dword v252, v250, s[24:27], 0 offen sc1
    s_mov_b64 exec, -1
L_NG1:
    v_mfma_f32_16x16x32_f16 v[16:19], v[128:131], v[192:195], 0
    v_mfma_f32_16x16x32_f16 v[20:23], v[132:135], v[192:195], 0
    ds_read_b128 v[192:195], v240 offset:12288
    v_mfma_f32_16x16x32_bf16 v[224:227], v[208:211], v[216:219], 0
    v_mfma_f32_16x16x32_bf16 v[232:235], v[208:211], v[220:223], 0
    ds_read_b64_tr_b16 v[208:209], v242 offset:34816
    v_mfma_f32_16x16x32_bf16 v[228:231], v[212:215], v[216:219], 0
    ds_read_b64_tr_b16 v[210:211], v242 offset:35072
    v_mfma_f32_16x16x32_bf16 v[236:239], v[212:215], v[220:223], 0
    ds_read_b64_tr_b16 v[212:213], v243 offset:34816
    s_waitcnt lgkmcnt(6)
    v_mfma_f32_16x16x32_f16 v[24:27], v[128:131], v[196:199], 0
    ds_read_b64_tr_b16 v[214:215], v243 offset:35072
    v_mfma_f32_16x16x32_f16 v[28:31], v[132:135], v[196:199], 0
    ds_read_b128 v[196:199], v240 offset:13312
    s_mov_b32 s63, 262144
    buffer_load_dwordx4 v[128:131], v246, s[20:23], s63 offen sc1
    s_waitcnt lgkmcnt(7)
    v_mfma_f32_16x16x32_f16 v[48:51], v[136:139], v[200:203], 0
    v_cvt_pk_f16_f32 v224, v224, v225
    v_cvt_pk_f16_f32 v225, v226, v227
    v_mfma_f32_16x16x32_f16 v[52:55], v[140:143], v[200:203], 0
    ds_read_b128 v[200:203], v241 offset:14336
    v_cvt_pk_f16_f32 v226, v228, v229
    s_waitcnt lgkmcnt(7)
    v_mfma_f32_16x16x32_f16 v[56:59], v[136:139], v[204:207], 0
    v_cvt_pk_f16_f32 v227, v230, v231
    ds_write_b128 v244, v[224:227] offset:0
    v_mfma_f32_16x16x32_f16 v[60:63], v[140:143], v[204:207], 0
    ds_read_b128 v[204:207], v241 offset:15360
    s_mov_b32 s41, 278528
    buffer_load_dwordx4 v[132:135], v246, s[20:23], s41 offen sc1
    s_waitcnt lgkmcnt(8)
    v_mfma_f32_16x16x32_f16 v[80:83], v[144:147], v[192:195], 0
    v_cvt_pk_f16_f32 v232, v232, v233
    v_cvt_pk_f16_f32 v233, v234, v235
    v_mfma_f32_16x16x32_f16 v[84:87], v[148:151], v[192:195], 0
    ds_read_b128 v[192:195], v240 offset:16384
    v_cvt_pk_f16_f32 v234, v236, v237
    s_waitcnt lgkmcnt(4)
    v_mfma_f32_16x16x32_f16 v[88:91], v[144:147], v[196:199], 0
    v_cvt_pk_f16_f32 v235, v238, v239
    ds_write_b128 v245, v[232:235] offset:26112
    v_mfma_f32_16x16x32_f16 v[92:95], v[148:151], v[196:199], 0
    ds_read_b128 v[196:199], v240 offset:17408
    s_mov_b32 s63, 294912
    buffer_load_dwordx4 v[136:139], v246, s[20:23], s63 offen sc1
    s_waitcnt lgkmcnt(5)
    v_mfma_f32_16x16x32_f16 v[112:115], v[152:155], v[200:203], 0
    v_mfma_f32_16x16x32_f16 v[116:119], v[156:159], v[200:203], 0
    ds_read_b128 v[200:203], v241 offset:18432
    s_waitcnt lgkmcnt(4)
    v_mfma_f32_16x16x32_f16 v[120:123], v[152:155], v[204:207], 0
    s_mov_b32 s41, 311296
    buffer_load_dwordx4 v[140:143], v246, s[20:23], s41 offen sc1
    v_mfma_f32_16x16x32_f16 v[124:127], v[156:159], v[204:207], 0
    ds_read_b128 v[204:207], v241 offset:19456
    s_waitcnt vmcnt(12)
    v_sub_u32 v255, v254, v255
    v_cmp_ne_u32 vcc, 0, v255
    v_readlane_b32 s44, v254, 7
    v_readlane_b32 s45, v254, 15
    s_lshr_b32 s62, vcc_lo, 8
    s_or_b32 s62, s62, vcc_lo
    s_sub_i32 s44, s55, s44
    s_lshl_b32 s56, s44, 23
    s_or_b32 s58, s56, 0x80400000
    s_add_u32 s60, s56, 0x00c00000
    s_sub_i32 s45, s55, s45
    s_lshl_b32 s57, s45, 23
    s_or_b32 s59, s57, 0x80400000
    s_add_u32 s61, s57, 0x00c00000
    s_waitcnt lgkmcnt(3)
    s_barrier
    s_bitcmp1_b32 s62, 1
    s_cbranch_scc1 L_RS1
L_RB1:
    s_waitcnt vmcnt(11)
    v_mfma_f32_16x16x32_f16 v[0:3], v[160:163], v[192:195], v[0:3]
    s_waitcnt vmcnt(10)
    v_mfma_f32_16x16x32_f16 v[4:7], v[164:167], v[192:195], v[4:7]
    ds_read_b128 v[192:195], v240 offset:20480
    v_mfma_f32_16x16x32_bf16 v[224:227], v[208:211], v[216:219], 0
    v_mfma_f32_16x16x32_bf16 v[232:235], v[208:211], v[220:223], 0
    ds_read_b64_tr_b16 v[208:209], v242 offset:43520
    v_mfma_f32_16x16x32_bf16 v[228:231], v[212:215], v[216:219], 0
    ds_read_b64_tr_b16 v[210:211], v242 offset:43776
    v_mfma_f32_16x16x32_bf16 v[236:239], v[212:215], v[220:223], 0
    ds_read_b64_tr_b16 v[212:213], v243 offset:43520
    s_waitcnt lgkmcnt(6)
    v_mfma_f32_16x16x32_f16 v[8:11], v[160:163], v[196:199], v[8:11]
    ds_read_b64_tr_b16 v[214:215], v243 offset:43776
    v_mfma_f32_16x16x32_f16 v[12:15], v[164:167], v[196:199], v[12:15]
    ds_read_b128 v[196:199], v240 offset:21504
    s_mov_b32 s63, 327680
    buffer_load_dwordx4 v[144:147], v246, s[20:23], s63 offen sc1
    s_waitcnt lgkmcnt(7)
    s_waitcnt vmcnt(10)
    v_mfma_f32_16x16x32_f16 v[32:35], v[168:171], v[200:203], v[32:35]
    v_cvt_pk_f16_f32 v224, v224, v225
    v_cvt_pk_f16_f32 v225, v226, v227
    s_waitcnt vmcnt(9)
    v_mfma_f32_16x16x32_f16 v[36:39], v[172:175], v[200:203], v[36:39]
    ds_read_b128 v[200:203], v241 offset:22528
    v_cvt_pk_f16_f32 v226, v228, v229
    s_waitcnt lgkmcnt(7)
    v_mfma_f32_16x16x32_f16 v[40:43], v[168:171], v[204:207], v[40:43]
    v_cvt_pk_f16_f32 v227, v230, v231
    ds_write_b128 v244, v[224:227] offset:8192
    v_mfma_f32_16x16x32_f16 v[44:47], v[172:175], v[204:207], v[44:47]
    ds_read_b128 v[204:207], v241 offset:23552
    s_mov_b32 s41, 344064
    buffer_load_dwordx4 v[148:151], v246, s[20:23], s41 offen sc1
    s_waitcnt lgkmcnt(8)
    s_waitcnt vmcnt(9)
    v_mfma_f32_16x16x32_f16 v[64:67], v[176:179], v[192:195], v[64:67]
    v_cvt_pk_f16_f32 v232, v232, v233
    v_cvt_pk_f16_f32 v233, v234, v235
    s_waitcnt vmcnt(8)
    v_mfma_f32_16x16x32_f16 v[68:71], v[180:183], v[192:195], v[68:71]
    ds_read_b128 v[192:195], v240 offset:0
    v_cvt_pk_f16_f32 v234, v236, v237
    s_waitcnt lgkmcnt(4)
    v_mfma_f32_16x16x32_f16 v[72:75], v[176:179], v[196:199], v[72:75]
    v_cvt_pk_f16_f32 v235, v238, v239
    ds_write_b128 v245, v[232:235] offset:34816
    v_mfma_f32_16x16x32_f16 v[76:79], v[180:183], v[196:199], v[76:79]
    ds_read_b128 v[196:199], v240 offset:1024
    s_mov_b32 s63, 360448
    buffer_load_dwordx4 v[152:155], v246, s[20:23], s63 offen sc1
    s_waitcnt lgkmcnt(5)
    s_waitcnt vmcnt(8)
    v_mfma_f32_16x16x32_f16 v[96:99], v[184:187], v[200:203], v[96:99]
    s_waitcnt vmcnt(7)
    v_mfma_f32_16x16x32_f16 v[100:103], v[188:191], v[200:203], v[100:103]
    ds_read_b128 v[200:203], v241 offset:2048
    s_waitcnt lgkmcnt(4)
    v_mfma_f32_16x16x32_f16 v[104:107], v[184:187], v[204:207], v[104:107]
    s_mov_b32 s41, 376832
    buffer_load_dwordx4 v[156:159], v246, s[20:23], s41 offen sc1
    v_mfma_f32_16x16x32_f16 v[108:111], v[188:191], v[204:207], v[108:111]
    ds_read_b128 v[204:207], v241 offset:3072
    s_waitcnt lgkmcnt(3)
    s_barrier
    v_mfma_f32_16x16x32_f16 v[16:19], v[160:163], v[192:195], v[16:19]
    v_mfma_f32_16x16x32_f16 v[20:23], v[164:167], v[192:195], v[20:23]
    ds_read_b128 v[192:195], v240 offset:4096
    v_mfma_f32_16x16x32_bf16 v[224:227], v[208:211], v[216:219], 0
    v_mfma_f32_16x16x32_bf16 v[232:235], v[208:211], v[220:223], 0
    ds_read_b64_tr_b16 v[208:209], v242 offset:52224
    v_mfma_f32_16x16x32_bf16 v[228:231], v[212:215], v[216:219], 0
    ds_read_b64_tr_b16 v[210:211], v242 offset:52480
    v_mfma_f32_16x16x32_bf16 v[236:239], v[212:215], v[220:223], 0
    ds_read_b64_tr_b16 v[212:213], v243 offset:52224
    s_waitcnt lgkmcnt(6)
    v_mfma_f32_16x16x32_f16 v[24:27], v[160:163], v[196:199], v[24:27]
    ds_read_b64_tr_b16 v[214:215], v243 offset:52480
    v_mfma_f32_16x16x32_f16 v[28:31], v[164:167], v[196:199], v[28:31]
    ds_read_b128 v[196:199], v240 offset:5120
    s_mov_b32 s63, 393216
    buffer_load_dwordx4 v[160:163], v246, s[20:23], s63 offen sc1
    s_waitcnt lgkmcnt(7)
    v_mfma_f32_16x16x32_f16 v[48:51], v[168:171], v[200:203], v[48:51]
    v_cvt_pk_f16_f32 v224, v224, v225
    v_cvt_pk_f16_f32 v225, v226, v227
    v_mfma_f32_16x16x32_f16 v[52:55], v[172:175], v[200:203], v[52:55]
    ds_read_b128 v[200:203], v241 offset:6144
    v_cvt_pk_f16_f32 v226, v228, v229
    s_waitcnt lgkmcnt(7)
    v_mfma_f32_16x16x32_f16 v[56:59], v[168:171], v[204:207], v[56:59]
    v_cvt_pk_f16_f32 v227, v230, v231
    ds_write_b128 v244, v[224:227] offset:16384
    v_mfma_f32_16x16x32_f16 v[60:63], v[172:175], v[204:207], v[60:63]
    ds_read_b128 v[204:207], v241 offset:7168
    s_mov_b32 s41, 409600
    buffer_load_dwordx4 v[164:167], v246, s[20:23], s41 offen sc1
    s_waitcnt lgkmcnt(8)
    v_mfma_f32_16x16x32_f16 v[80:83], v[176:179], v[192:195], v[80:83]
    v_cvt_pk_f16_f32 v232, v232, v233
    v_cvt_pk_f16_f32 v233, v234, v235
    v_mfma_f32_16x16x32_f16 v[84:87], v[180:183], v[192:195], v[84:87]
    ds_read_b128 v[192:195], v240 offset:8192
    v_cvt_pk_f16_f32 v234, v236, v237
    s_waitcnt lgkmcnt(4)
    v_mfma_f32_16x16x32_f16 v[88:91], v[176:179], v[196:199], v[88:91]
    v_cvt_pk_f16_f32 v235, v238, v239
    ds_write_b128 v245, v[232:235] offset:43520
    v_mfma_f32_16x16x32_f16 v[92:95], v[180:183], v[196:199], v[92:95]
    ds_read_b128 v[196:199], v240 offset:9216
    s_mov_b32 s63, 425984
    buffer_load_dwordx4 v[168:171], v246, s[20:23], s63 offen sc1
    s_waitcnt lgkmcnt(5)
    v_mfma_f32_16x16x32_f16 v[112:115], v[184:187], v[200:203], v[112:115]
    v_mfma_f32_16x16x32_f16 v[116:119], v[188:191], v[200:203], v[116:119]
    ds_read_b128 v[200:203], v241 offset:10240
    s_waitcnt lgkmcnt(4)
    v_mfma_f32_16x16x32_f16 v[120:123], v[184:187], v[204:207], v[120:123]
    s_mov_b32 s41, 442368
    buffer_load_dwordx4 v[172:175], v246, s[20:23], s41 offen sc1
    v_mfma_f32_16x16x32_f16 v[124:127], v[188:191], v[204:207], v[124:127]
    ds_read_b128 v[204:207], v241 offset:11264
    s_waitcnt lgkmcnt(3)
    s_barrier
    s_bitcmp1_b32 s62, 2
    s_cbranch_scc1 L_RS2
L_RB2:
    s_waitcnt vmcnt(11)
    v_mfma_f32_16x16x32_f16 v[0:3], v[128:131], v[192:195], v[0:3]
    s_waitcnt vmcnt(10)
    v_mfma_f32_16x16x32_f16 v[4:7], v[132:135], v[192:195], v[4:7]
    ds_read_b128 v[192:195], v240 offset:12288
    v_mfma_f32_16x16x32_bf16 v[224:227], v[208:211], v[216:219], 0
    v_mfma_f32_16x16x32_bf16 v[232:235], v[208:211], v[220:223], 0
    ds_read_b64_tr_b16 v[208:209], v242 offset:60928
    v_mfma_f32_16x16x32_bf16 v[228:231], v[212:215], v[216:219], 0
    ds_read_b64_tr_b16 v[210:211], v242 offset:61184
    v_mfma_f32_16x16x32_bf16 v[236:239], v[212:215], v[220:223], 0
    ds_read_b64_tr_b16 v[212:213], v243 offset:60928
    s_waitcnt lgkmcnt(6)
    v_mfma_f32_16x16x32_f16 v[8:11], v[128:131], v[196:199], v[8:11]
    ds_read_b64_tr_b16 v[214:215], v243 offset:61184
    v_mfma_f32_16x16x32_f16 v[12:15], v[132:135], v[196:199], v[12:15]
    ds_read_b128 v[196:199], v240 offset:13312
    s_mov_b32 s63, 458752
    buffer_load_dwordx4 v[176:179], v246, s[20:23], s63 offen sc1
    s_waitcnt lgkmcnt(7)
    s_waitcnt vmcnt(10)
    v_mfma_f32_16x16x32_f16 v[32:35], v[136:139], v[200:203], v[32:35]
    v_cvt_pk_f16_f32 v224, v224, v225
    v_cvt_pk_f16_f32 v225, v226, v227
    s_waitcnt vmcnt(9)
    v_mfma_f32_16x16x32_f16 v[36:39], v[140:143], v[200:203], v[36:39]
    ds_read_b128 v[200:203], v241 offset:14336
    v_cvt_pk_f16_f32 v226, v228, v229
    s_waitcnt lgkmcnt(7)
    v_mfma_f32_16x16x32_f16 v[40:43], v[136:139], v[204:207], v[40:43]
    v_cvt_pk_f16_f32 v227, v230, v231
    ds_write_b128 v244, v[224:227] offset:0
    v_mfma_f32_16x16x32_f16 v[44:47], v[140:143], v[204:207], v[44:47]
    ds_read_b128 v[204:207], v241 offset:15360
    s_mov_b32 s41, 475136
    buffer_load_dwordx4 v[180:183], v246, s[20:23], s41 offen sc1
    s_waitcnt lgkmcnt(8)
    s_waitcnt vmcnt(9)
    v_mfma_f32_16x16x32_f16 v[64:67], v[144:147], v[192:195], v[64:67]
    v_cvt_pk_f16_f32 v232, v232, v233
    v_cvt_pk_f16_f32 v233, v234, v235
    s_waitcnt vmcnt(8)
    v_mfma_f32_16x16x32_f16 v[68:71], v[148:151], v[192:195], v[68:71]
    ds_read_b128 v[192:195], v240 offset:16384
    v_cvt_pk_f16_f32 v234, v236, v237
    s_waitcnt lgkmcnt(4)
    v_mfma_f32_16x16x32_f16 v[72:75], v[144:147], v[196:199], v[72:75]
    v_cvt_pk_f16_f32 v235, v238, v239
    ds_write_b128 v245, v[232:235] offset:52224
    v_mfma_f32_16x16x32_f16 v[76:79], v[148:151], v[196:199], v[76:79]
    ds_read_b128 v[196:199], v240 offset:17408
    s_mov_b32 s63, 491520
    buffer_load_dwordx4 v[184:187], v246, s[20:23], s63 offen sc1
    s_waitcnt lgkmcnt(5)
    s_waitcnt vmcnt(8)
    v_mfma_f32_16x16x32_f16 v[96:99], v[152:155], v[200:203], v[96:99]
    s_waitcnt vmcnt(7)
    v_mfma_f32_16x16x32_f16 v[100:103], v[156:159], v[200:203], v[100:103]
    ds_read_b128 v[200:203], v241 offset:18432
    s_waitcnt lgkmcnt(4)
    v_mfma_f32_16x16x32_f16 v[104:107], v[152:155], v[204:207], v[104:107]
    s_mov_b32 s41, 507904
    buffer_load_dwordx4 v[188:191], v246, s[20:23], s41 offen sc1
    v_mfma_f32_16x16x32_f16 v[108:111], v[156:159], v[204:207], v[108:111]
    ds_read_b128 v[204:207], v241 offset:19456
    s_waitcnt lgkmcnt(3)
    s_barrier
    v_mfma_f32_16x16x32_f16 v[16:19], v[128:131], v[192:195], v[16:19]
    v_mfma_f32_16x16x32_f16 v[20:23], v[132:135], v[192:195], v[20:23]
    ds_read_b128 v[192:195], v240 offset:20480
    v_mfma_f32_16x16x32_bf16 v[224:227], v[208:211], v[216:219], 0
    v_mfma_f32_16x16x32_bf16 v[232:235], v[208:211], v[220:223], 0
    v_add_u32 v242, 69632, v242
    ds_read_b64_tr_b16 v[208:209], v242 offset:0
    v_mfma_f32_16x16x32_bf16 v[228:231], v[212:215], v[216:219], 0
    ds_read_b64_tr_b16 v[210:211], v242 offset:256
    v_mfma_f32_16x16x32_bf16 v[236:239], v[212:215], v[220:223], 0
    v_add_u32 v243, 69632, v243
    ds_read_b64_tr_b16 v[212:213], v243 offset:0
    s_waitcnt lgkmcnt(6)
    v_mfma_f32_16x16x32_f16 v[24:27], v[128:131], v[196:199], v[24:27]
    ds_read_b64_tr_b16 v[214:215], v243 offset:256
    v_mfma_f32_16x16x32_f16 v[28:31], v[132:135], v[196:199], v[28:31]
    ds_read_b128 v[196:199], v240 offset:21504
    s_mov_b32 s63, 524288
    buffer_load_dwordx4 v[128:131], v246, s[20:23], s63 offen sc1
    s_waitcnt lgkmcnt(7)
    v_mfma_f32_16x16x32_f16 v[48:51], v[136:139], v[200:203], v[48:51]
    v_cvt_pk_f16_f32 v224, v224, v225
    v_cvt_pk_f16_f32 v225, v226, v227
    v_mfma_f32_16x16x32_f16 v[52:55], v[140:143], v[200:203], v[52:55]
    ds_read_b128 v[200:203], v241 offset:22528
    v_cvt_pk_f16_f32 v226, v228, v229
    s_waitcnt lgkmcnt(7)
    v_mfma_f32_16x16x32_f16 v[56:59], v[136:139], v[204:207], v[56:59]
    v_cvt_pk_f16_f32 v227, v230, v231
    ds_write_b128 v244, v[224:227] offset:8192
    v_mfma_f32_16x16x32_f16 v[60:63], v[140:143], v[204:207], v[60:63]
    ds_read_b128 v[204:207], v241 offset:23552
    s_mov_b32 s41, 540672
    buffer_load_dwordx4 v[132:135], v246, s[20:23], s41 offen sc1
    s_waitcnt lgkmcnt(8)
    v_mfma_f32_16x16x32_f16 v[80:83], v[144:147], v[192:195], v[80:83]
    v_cvt_pk_f16_f32 v232, v232, v233
    v_cvt_pk_f16_f32 v233, v234, v235
    v_mfma_f32_16x16x32_f16 v[84:87], v[148:151], v[192:195], v[84:87]
    ds_read_b128 v[192:195], v240 offset:0
    v_cvt_pk_f16_f32 v234, v236, v237
    s_waitcnt lgkmcnt(4)
    v_mfma_f32_16x16x32_f16 v[88:91], v[144:147], v[196:199], v[88:91]
    v_cvt_pk_f16_f32 v235, v238, v239
    ds_write_b128 v245, v[232:235] offset:60928
    v_mfma_f32_16x16x32_f16 v[92:95], v[148:151], v[196:199], v[92:95]
    ds_read_b128 v[196:199], v240 offset:1024
    s_mov_b32 s63, 557056
    buffer_load_dwordx4 v[136:139], v246, s[20:23], s63 offen sc1
    s_waitcnt lgkmcnt(5)
    v_mfma_f32_16x16x32_f16 v[112:115], v[152:155], v[200:203], v[112:115]
    v_mfma_f32_16x16x32_f16 v[116:119], v[156:159], v[200:203], v[116:119]
    ds_read_b128 v[200:203], v241 offset:2048
    s_waitcnt lgkmcnt(4)
    v_mfma_f32_16x16x32_f16 v[120:123], v[152:155], v[204:207], v[120:123]
    s_mov_b32 s41, 573440
    buffer_load_dwordx4 v[140:143], v246, s[20:23], s41 offen sc1
    v_mfma_f32_16x16x32_f16 v[124:127], v[156:159], v[204:207], v[124:127]
    ds_read_b128 v[204:207], v241 offset:3072
    s_waitcnt lgkmcnt(3)
    s_barrier
    s_bitcmp1_b32 s62, 3
    s_cbranch_scc1 L_RS3
L_RB3:
    s_waitcnt vmcnt(11)
    v_mfma_f32_16x16x32_f16 v[0:3], v[160:163], v[192:195], v[0:3]
    s_waitcnt vmcnt(10)
    v_mfma_f32_16x16x32_f16 v[4:7], v[164:167], v[192:195], v[4:7]
    ds_read_b128 v[192:195], v240 offset:4096
    v_mfma_f32_16x16x32_bf16 v[224:227], v[208:211], v[216:219], 0
    v_mfma_f32_16x16x32_bf16 v[232:235], v[208:211], v[220:223], 0
    ds_read_b64_tr_b16 v[208:209], v242 offset:8704
    v_mfma_f32_16x16x32_bf16 v[228:231], v[212:215], v[216:219], 0
    ds_read_b64_tr_b16 v[210:211], v242 offset:8960
    v_mfma_f32_16x16x32_bf16 v[236:239], v[212:215], v[220:223], 0
    ds_read_b64_tr_b16 v[212:213], v243 offset:8704
    s_waitcnt lgkmcnt(6)
    v_mfma_f32_16x16x32_f16 v[8:11], v[160:163], v[196:199], v[8:11]
    ds_read_b64_tr_b16 v[214:215], v243 offset:8960
    v_mfma_f32_16x16x32_f16 v[12:15], v[164:167], v[196:199], v[12:15]
    ds_read_b128 v[196:199], v240 offset:5120
    s_mov_b32 s63, 589824
    buffer_load_dwordx4 v[144:147], v246, s[20:23], s63 offen sc1
    s_waitcnt lgkmcnt(7)
    s_waitcnt vmcnt(10)
    v_mfma_f32_16x16x32_f16 v[32:35], v[168:171], v[200:203], v[32:35]
    v_cvt_pk_f16_f32 v224, v224, v225
    v_cvt_pk_f16_f32 v225, v226, v227
    s_waitcnt vmcnt(9)
    v_mfma_f32_16x16x32_f16 v[36:39], v[172:175], v[200:203], v[36:39]
    ds_read_b128 v[200:203], v241 offset:6144
    v_cvt_pk_f16_f32 v226, v228, v229
    s_waitcnt lgkmcnt(7)
    v_mfma_f32_16x16x32_f16 v[40:43], v[168:171], v[204:207], v[40:43]
    v_cvt_pk_f16_f32 v227, v230, v231
    ds_write_b128 v244, v[224:227] offset:16384
    v_mfma_f32_16x16x32_f16 v[44:47], v[172:175], v[204:207], v[44:47]
    ds_read_b128 v[204:207], v241 offset:7168
    s_mov_b32 s41, 606208
    buffer_load_dwordx4 v[148:151], v246, s[20:23], s41 offen sc1
    s_waitcnt lgkmcnt(8)
    s_waitcnt vmcnt(9)
    v_mfma_f32_16x16x32_f16 v[64:67], v[176:179], v[192:195], v[64:67]
    v_cvt_pk_f16_f32 v232, v232, v233
    v_cvt_pk_f16_f32 v233, v234, v235
    s_waitcnt vmcnt(8)
    v_mfma_f32_16x16x32_f16 v[68:71], v[180:183], v[192:195], v[68:71]
    ds_read_b128 v[192:195], v240 offset:8192
    v_cvt_pk_f16_f32 v234, v236, v237
    s_waitcnt lgkmcnt(4)
    v_mfma_f32_16x16x32_f16 v[72:75], v[176:179], v[196:199], v[72:75]
    v_cvt_pk_f16_f32 v235, v238, v239
    v_add_u32 v245, 69632, v245
    ds_write_b128 v245, v[232:235] offset:0
    v_mfma_f32_16x16x32_f16 v[76:79], v[180:183], v[196:199], v[76:79]
    ds_read_b128 v[196:199], v240 offset:9216
    s_mov_b32 s63, 622592
    buffer_load_dwordx4 v[152:155], v246, s[20:23], s63 offen sc1
    s_waitcnt lgkmcnt(5)
    s_waitcnt vmcnt(8)
    v_mfma_f32_16x16x32_f16 v[96:99], v[184:187], v[200:203], v[96:99]
    s_waitcnt vmcnt(7)
    v_mfma_f32_16x16x32_f16 v[100:103], v[188:191], v[200:203], v[100:103]
    ds_read_b128 v[200:203], v241 offset:10240
    s_waitcnt lgkmcnt(4)
    v_mfma_f32_16x16x32_f16 v[104:107], v[184:187], v[204:207], v[104:107]
    s_mov_b32 s41, 638976
    buffer_load_dwordx4 v[156:159], v246, s[20:23], s41 offen sc1
    v_mfma_f32_16x16x32_f16 v[108:111], v[188:191], v[204:207], v[108:111]
    ds_read_b128 v[204:207], v241 offset:11264
    s_waitcnt lgkmcnt(3)
    s_barrier
    v_mfma_f32_16x16x32_f16 v[16:19], v[160:163], v[192:195], v[16:19]
    v_mfma_f32_16x16x32_f16 v[20:23], v[164:167], v[192:195], v[20:23]
    ds_read_b128 v[192:195], v240 offset:12288
    v_mfma_f32_16x16x32_bf16 v[224:227], v[208:211], v[216:219], 0
    v_mfma_f32_16x16x32_bf16 v[232:235], v[208:211], v[220:223], 0
    ds_read_b64_tr_b16 v[208:209], v242 offset:17408
    v_mfma_f32_16x16x32_bf16 v[228:231], v[212:215], v[216:219], 0
    ds_read_b64_tr_b16 v[210:211], v242 offset:17664
    v_mfma_f32_16x16x32_bf16 v[236:239], v[212:215], v[220:223], 0
    ds_read_b64_tr_b16 v[212:213], v243 offset:17408
    s_waitcnt lgkmcnt(6)
    v_mfma_f32_16x16x32_f16 v[24:27], v[160:163], v[196:199], v[24:27]
    ds_read_b64_tr_b16 v[214:215], v243 offset:17664
    v_mfma_f32_16x16x32_f16 v[28:31], v[164:167], v[196:199], v[28:31]
    ds_read_b128 v[196:199], v240 offset:13312
    s_mov_b32 s63, 655360
    buffer_load_dwordx4 v[160:163], v246, s[20:23], s63 offen sc1
    s_waitcnt lgkmcnt(7)
    v_mfma_f32_16x16x32_f16 v[48:51], v[168:171], v[200:203], v[48:51]
    v_cvt_pk_f16_f32 v224, v224, v225
    v_cvt_pk_f16_f32 v225, v226, v227
    v_mfma_f32_16x16x32_f16 v[52:55], v[172:175], v[200:203], v[52:55]
    ds_read_b128 v[200:203], v241 offset:14336
    v_cvt_pk_f16_f32 v226, v228, v229
    s_waitcnt lgkmcnt(7)
    v_mfma_f32_16x16x32_f16 v[56:59], v[168:171], v[204:207], v[56:59]
    v_cvt_pk_f16_f32 v227, v230, v231
    ds_write_b128 v244, v[224:227] offset:0
    v_mfma_f32_16x16x32_f16 v[60:63], v[172:175], v[204:207], v[60:63]
    ds_read_b128 v[204:207], v241 offset:15360
    s_mov_b32 s41, 671744
    buffer_load_dwordx4 v[164:167], v246, s[20:23], s41 offen sc1
    s_waitcnt lgkmcnt(8)
    v_mfma_f32_16x16x32_f16 v[80:83], v[176:179], v[192:195], v[80:83]
    v_cvt_pk_f16_f32 v232, v232, v233
    v_cvt_pk_f16_f32 v233, v234, v235
    v_mfma_f32_16x16x32_f16 v[84:87], v[180:183], v[192:195], v[84:87]
    ds_read_b128 v[192:195], v240 offset:16384
    v_cvt_pk_f16_f32 v234, v236, v237
    s_waitcnt lgkmcnt(4)
    v_mfma_f32_16x16x32_f16 v[88:91], v[176:179], v[196:199], v[88:91]
    v_cvt_pk_f16_f32 v235, v238, v239
    ds_write_b128 v245, v[232:235] offset:8704
    v_mfma_f32_16x16x32_f16 v[92:95], v[180:183], v[196:199], v[92:95]
    ds_read_b128 v[196:199], v240 offset:17408
    s_mov_b32 s63, 688128
    buffer_load_dwordx4 v[168:171], v246, s[20:23], s63 offen sc1
    s_waitcnt lgkmcnt(5)
    v_mfma_f32_16x16x32_f16 v[112:115], v[184:187], v[200:203], v[112:115]
    v_mfma_f32_16x16x32_f16 v[116:119], v[188:191], v[200:203], v[116:119]
    ds_read_b128 v[200:203], v241 offset:18432
    s_waitcnt lgkmcnt(4)
    v_mfma_f32_16x16x32_f16 v[120:123], v[184:187], v[204:207], v[120:123]
    s_mov_b32 s41, 704512
    buffer_load_dwordx4 v[172:175], v246, s[20:23], s41 offen sc1
    v_mfma_f32_16x16x32_f16 v[124:127], v[188:191], v[204:207], v[124:127]
    ds_read_b128 v[204:207], v241 offset:19456
    s_waitcnt lgkmcnt(3)
    s_barrier
    s_bitcmp1_b32 s62, 4
    s_cbranch_scc1 L_RS4
L_RB4:
    s_waitcnt vmcnt(11)
    v_mfma_f32_16x16x32_f16 v[0:3], v[128:131], v[192:195], v[0:3]
    s_waitcnt vmcnt(10)
    v_mfma_f32_16x16x32_f16 v[4:7], v[132:135], v[192:195], v[4:7]
    ds_read_b128 v[192:195], v240 offset:20480
    v_mfma_f32_16x16x32_bf16 v[224:227], v[208:211], v[216:219], 0
    v_mfma_f32_16x16x32_bf16 v[232:235], v[208:211], v[220:223], 0
    ds_read_b64_tr_b16 v[208:209], v242 offset:26112
    v_mfma_f32_16x16x32_bf16 v[228:231], v[212:215], v[216:219], 0
    ds_read_b64_tr_b16 v[210:211], v242 offset:26368
    v_mfma_f32_16x16x32_bf16 v[236:239], v[212:215], v[220:223], 0
    ds_read_b64_tr_b16 v[212:213], v243 offset:26112
    s_waitcnt lgkmcnt(6)
    v_mfma_f32_16x16x32_f16 v[8:11], v[128:131], v[196:199], v[8:11]
    ds_read_b64_tr_b16 v[214:215], v243 offset:26368
    v_mfma_f32_16x16x32_f16 v[12:15], v[132:135], v[196:199], v[12:15]
    ds_read_b128 v[196:199], v240 offset:21504
    s_mov_b32 s63, 720896
    buffer_load_dwordx4 v[176:179], v246, s[20:23], s63 offen sc1
    s_waitcnt lgkmcnt(7)
    s_waitcnt vmcnt(10)
    v_mfma_f32_16x16x32_f16 v[32:35], v[136:139], v[200:203], v[32:35]
    v_cvt_pk_f16_f32 v224, v224, v225
    v_cvt_pk_f16_f32 v225, v226, v227
    s_waitcnt vmcnt(9)
    v_mfma_f32_16x16x32_f16 v[36:39], v[140:143], v[200:203], v[36:39]
    ds_read_b128 v[200:203], v241 offset:22528
    v_cvt_pk_f16_f32 v226, v228, v229
    s_waitcnt lgkmcnt(7)
    v_mfma_f32_16x16x32_f16 v[40:43], v[136:139], v[204:207], v[40:43]
    v_cvt_pk_f16_f32 v227, v230, v231
    ds_write_b128 v244, v[224:227] offset:8192
    v_mfma_f32_16x16x32_f16 v[44:47], v[140:143], v[204:207], v[44:47]
    ds_read_b128 v[204:207], v241 offset:23552
    s_mov_b32 s41, 737280
    buffer_load_dwordx4 v[180:183], v246, s[20:23], s41 offen sc1
    s_waitcnt lgkmcnt(8)
    s_waitcnt vmcnt(9)
    v_mfma_f32_16x16x32_f16 v[64:67], v[144:147], v[192:195], v[64:67]
    v_cvt_pk_f16_f32 v232, v232, v233
    v_cvt_pk_f16_f32 v233, v234, v235
    s_waitcnt vmcnt(8)
    v_mfma_f32_16x16x32_f16 v[68:71], v[148:151], v[192:195], v[68:71]
    ds_read_b128 v[192:195], v240 offset:0
    v_cvt_pk_f16_f32 v234, v236, v237
    s_waitcnt lgkmcnt(4)
    v_mfma_f32_16x16x32_f16 v[72:75], v[144:147], v[196:199], v[72:75]
    v_cvt_pk_f16_f32 v235, v238, v239
    ds_write_b128 v245, v[232:235] offset:17408
    v_mfma_f32_16x16x32_f16 v[76:79], v[148:151], v[196:199], v[76:79]
    ds_read_b128 v[196:199], v240 offset:1024
    s_mov_b32 s63, 753664
    buffer_load_dwordx4 v[184:187], v246, s[20:23], s63 offen sc1
    s_waitcnt lgkmcnt(5)
    s_waitcnt vmcnt(8)
    v_mfma_f32_16x16x32_f16 v[96:99], v[152:155], v[200:203], v[96:99]
    s_waitcnt vmcnt(7)
    v_mfma_f32_16x16x32_f16 v[100:103], v[156:159], v[200:203], v[100:103]
    ds_read_b128 v[200:203], v241 offset:2048
    s_waitcnt lgkmcnt(4)
    v_mfma_f32_16x16x32_f16 v[104:107], v[152:155], v[204:207], v[104:107]
    s_mov_b32 s41, 770048
    buffer_load_dwordx4 v[188:191], v246, s[20:23], s41 offen sc1
    v_mfma_f32_16x16x32_f16 v[108:111], v[156:159], v[204:207], v[108:111]
    ds_read_b128 v[204:207], v241 offset:3072
    s_waitcnt lgkmcnt(3)
    s_barrier
    v_mfma_f32_16x16x32_f16 v[16:19], v[128:131], v[192:195], v[16:19]
    v_mfma_f32_16x16x32_f16 v[20:23], v[132:135], v[192:195], v[20:23]
    ds_read_b128 v[192:195], v240 offset:4096
    v_mfma_f32_16x16x32_bf16 v[224:227], v[208:211], v[216:219], 0
    v_mfma_f32_16x16x32_bf16 v[232:235], v[208:211], v[220:223], 0
    ds_read_b64_tr_b16 v[208:209], v242 offset:34816
    v_mfma_f32_16x16x32_bf16 v[228:231], v[212:215], v[216:219], 0
    ds_read_b64_tr_b16 v[210:211], v242 offset:35072
    v_mfma_f32_16x16x32_bf16 v[236:239], v[212:215], v[220:223], 0
    ds_read_b64_tr_b16 v[212:213], v243 offset:34816
    s_waitcnt lgkmcnt(6)
    v_mfma_f32_16x16x32_f16 v[24:27], v[128:131], v[196:199], v[24:27]
    ds_read_b64_tr_b16 v[214:215], v243 offset:35072
    v_mfma_f32_16x16x32_f16 v[28:31], v[132:135], v[196:199], v[28:31]
    ds_read_b128 v[196:199], v240 offset:5120
    s_mov_b32 s63, 786432
    buffer_load_dwordx4 v[128:131], v246, s[20:23], s63 offen sc1
    s_waitcnt lgkmcnt(7)
    v_mfma_f32_16x16x32_f16 v[48:51], v[136:139], v[200:203], v[48:51]
    v_cvt_pk_f16_f32 v224, v224, v225
    v_cvt_pk_f16_f32 v225, v226, v227
    v_mfma_f32_16x16x32_f16 v[52:55], v[140:143], v[200:203], v[52:55]
    ds_read_b128 v[200:203], v241 offset:6144
    v_cvt_pk_f16_f32 v226, v228, v229
    s_waitcnt lgkmcnt(7)
    v_mfma_f32_16x16x32_f16 v[56:59], v[136:139], v[204:207], v[56:59]
    v_cvt_pk_f16_f32 v227, v230, v231
    ds_write_b128 v244, v[224:227] offset:16384
    v_mfma_f32_16x16x32_f16 v[60:63], v[140:143], v[204:207], v[60:63]
    ds_read_b128 v[204:207], v241 offset:7168
    s_mov_b32 s41, 802816
    buffer_load_dwordx4 v[132:135], v246, s[20:23], s41 offen sc1
    s_waitcnt lgkmcnt(8)
    v_mfma_f32_16x16x32_f16 v[80:83], v[144:147], v[192:195], v[80:83]
    v_cvt_pk_f16_f32 v232, v232, v233
    v_cvt_pk_f16_f32 v233, v234, v235
    v_mfma_f32_16x16x32_f16 v[84:87], v[148:151], v[192:195], v[84:87]
    ds_read_b128 v[192:195], v240 offset:8192
    v_cvt_pk_f16_f32 v234, v236, v237
    s_waitcnt lgkmcnt(4)
    v_mfma_f32_16x16x32_f16 v[88:91], v[144:147], v[196:199], v[88:91]
    v_cvt_pk_f16_f32 v235, v238, v239
    ds_write_b128 v245, v[232:235] offset:26112
    v_mfma_f32_16x16x32_f16 v[92:95], v[148:151], v[196:199], v[92:95]
    ds_read_b128 v[196:199], v240 offset:9216
    s_mov_b32 s63, 819200
    buffer_load_dwordx4 v[136:139], v246, s[20:23], s63 offen sc1
    s_waitcnt lgkmcnt(5)
    v_mfma_f32_16x16x32_f16 v[112:115], v[152:155], v[200:203], v[112:115]
    v_mfma_f32_16x16x32_f16 v[116:119], v[156:159], v[200:203], v[116:119]
    ds_read_b128 v[200:203], v241 offset:10240
    s_waitcnt lgkmcnt(4)
    v_mfma_f32_16x16x32_f16 v[120:123], v[152:155], v[204:207], v[120:123]
    s_mov_b32 s41, 835584
    buffer_load_dwordx4 v[140:143], v246, s[20:23], s41 offen sc1
    v_mfma_f32_16x16x32_f16 v[124:127], v[156:159], v[204:207], v[124:127]
    ds_read_b128 v[204:207], v241 offset:11264
    s_waitcnt lgkmcnt(3)
    s_barrier
    s_bitcmp1_b32 s62, 5
    s_cbranch_scc1 L_RS5
L_RB5:
    buffer_load_dword v252, v253, s[24:27], 0 offen offset:128 sc1
    s_waitcnt vmcnt(12)
    v_mfma_f32_16x16x32_f16 v[0:3], v[160:163], v[192:195], v[0:3]
    s_waitcnt vmcnt(11)
    v_mfma_f32_16x16x32_f16 v[4:7], v[164:167], v[192:195], v[4:7]
    ds_read_b128 v[192:195], v240 offset:12288
    v_mfma_f32_16x16x32_bf16 v[224:227], v[208:211], v[216:219], 0
    v_mfma_f32_16x16x32_bf16 v[232:235], v[208:211], v[220:223], 0
    ds_read_b64_tr_b16 v[208:209], v242 offset:43520
    v_mfma_f32_16x16x32_bf16 v[228:231], v[212:215], v[216:219], 0
    ds_read_b64_tr_b16 v[210:211], v242 offset:43776
    v_mfma_f32_16x16x32_bf16 v[236:239], v[212:215], v[220:223], 0
    ds_read_b64_tr_b16 v[212:213], v243 offset:43520
    s_waitcnt lgkmcnt(6)
    v_mfma_f32_16x16x32_f16 v[8:11], v[160:163], v[196:199], v[8:11]
    ds_read_b64_tr_b16 v[214:215], v243 offset:43776
    v_mfma_f32_16x16x32_f16 v[12:15], v[164:167], v[196:199], v[12:15]
    ds_read_b128 v[196:199], v240 offset:13312
    s_mov_b32 s63, 851968
    buffer_load_dwordx4 v[144:147], v246, s[20:23], s63 offen sc1
    s_waitcnt lgkmcnt(7)
    s_waitcnt vmcnt(11)
    v_mfma_f32_16x16x32_f16 v[32:35], v[168:171], v[200:203], v[32:35]
    v_cvt_pk_f16_f32 v224, v224, v225
    v_cvt_pk_f16_f32 v225, v226, v227
    s_waitcnt vmcnt(10)
    v_mfma_f32_16x16x32_f16 v[36:39], v[172:175], v[200:203], v[36:39]
    ds_read_b128 v[200:203], v241 offset:14336
    v_cvt_pk_f16_f32 v226, v228, v229
    s_waitcnt lgkmcnt(7)
    v_mfma_f32_16x16x32_f16 v[40:43], v[168:171], v[204:207], v[40:43]
    v_cvt_pk_f16_f32 v227, v230, v231
    ds_write_b128 v244, v[224:227] offset:0
    v_mfma_f32_16x16x32_f16 v[44:47], v[172:175], v[204:207], v[44:47]
    ds_read_b128 v[204:207], v241 offset:15360
    s_mov_b32 s41, 868352
    buffer_load_dwordx4 v[148:151], v246, s[20:23], s41 offen sc1
    s_waitcnt lgkmcnt(8)
    s_waitcnt vmcnt(10)
    v_mfma_f32_16x16x32_f16 v[64:67], v[176:179], v[192:195], v[64:67]
    v_cvt_pk_f16_f32 v232, v232, v233
    v_cvt_pk_f16_f32 v233, v234, v235
    s_waitcnt vmcnt(9)
    v_mfma_f32_16x16x32_f16 v[68:71], v[180:183], v[192:195], v[68:71]
    ds_read_b128 v[192:195], v240 offset:16384
    v_cvt_pk_f16_f32 v234, v236, v237
    s_waitcnt lgkmcnt(4)
    v_mfma_f32_16x16x32_f16 v[72:75], v[176:179], v[196:199], v[72:75]
    v_cvt_pk_f16_f32 v235, v238, v239
    ds_write_b128 v245, v[232:235] offset:34816
    v_mfma_f32_16x16x32_f16 v[76:79], v[180:183], v[196:199], v[76:79]
    ds_read_b128 v[196:199], v240 offset:17408
    s_mov_b32 s63, 884736
    buffer_load_dwordx4 v[152:155], v246, s[20:23], s63 offen sc1
    s_waitcnt lgkmcnt(5)
    s_waitcnt vmcnt(9)
    v_mfma_f32_16x16x32_f16 v[96:99], v[184:187], v[200:203], v[96:99]
    s_waitcnt vmcnt(8)
    v_mfma_f32_16x16x32_f16 v[100:103], v[188:191], v[200:203], v[100:103]
    ds_read_b128 v[200:203], v241 offset:18432
    s_waitcnt lgkmcnt(4)
    v_mfma_f32_16x16x32_f16 v[104:107], v[184:187], v[204:207], v[104:107]
    s_mov_b32 s41, 901120
    buffer_load_dwordx4 v[156:159], v246, s[20:23], s41 offen sc1
    v_mfma_f32_16x16x32_f16 v[108:111], v[188:191], v[204:207], v[108:111]
    ds_read_b128 v[204:207], v241 offset:19456
    s_waitcnt lgkmcnt(3)
    s_barrier
    v_mfma_f32_16x16x32_f16 v[16:19], v[160:163], v[192:195], v[16:19]
    v_mfma_f32_16x16x32_f16 v[20:23], v[164:167], v[192:195], v[20:23]
    ds_read_b128 v[192:195], v240 offset:20480
    v_mfma_f32_16x16x32_bf16 v[224:227], v[208:211], v[216:219], 0
    v_mfma_f32_16x16x32_bf16 v[232:235], v[208:211], v[220:223], 0
    ds_read_b64_tr_b16 v[208:209], v242 offset:52224
    v_mfma_f32_16x16x32_bf16 v[228:231], v[212:215], v[216:219], 0
    ds_read_b64_tr_b16 v[210:211], v242 offset:52480
    v_mfma_f32_16x16x32_bf16 v[236:239], v[212:215], v[220:223], 0
    ds_read_b64_tr_b16 v[212:213], v243 offset:52224
    s_waitcnt lgkmcnt(6)
    v_mfma_f32_16x16x32_f16 v[24:27], v[160:163], v[196:199], v[24:27]
    ds_read_b64_tr_b16 v[214:215], v243 offset:52480
    v_mfma_f32_16x16x32_f16 v[28:31], v[164:167], v[196:199], v[28:31]
    ds_read_b128 v[196:199], v240 offset:21504
    s_mov_b32 s63, 917504
    buffer_load_dwordx4 v[160:163], v246, s[20:23], s63 offen sc1
    s_waitcnt lgkmcnt(7)
    v_mfma_f32_16x16x32_f16 v[48:51], v[168:171], v[200:203], v[48:51]
    v_cvt_pk_f16_f32 v224, v224, v225
    v_cvt_pk_f16_f32 v225, v226, v227
    v_mfma_f32_16x16x32_f16 v[52:55], v[172:175], v[200:203], v[52:55]
    ds_read_b128 v[200:203], v241 offset:22528
    v_cvt_pk_f16_f32 v226, v228, v229
    s_waitcnt lgkmcnt(7)
    v_mfma_f32_16x16x32_f16 v[56:59], v[168:171], v[204:207], v[56:59]
    v_cvt_pk_f16_f32 v227, v230, v231
    ds_write_b128 v244, v[224:227] offset:8192
    v_mfma_f32_16x16x32_f16 v[60:63], v[172:175], v[204:207], v[60:63]
    ds_read_b128 v[204:207], v241 offset:23552
    s_mov_b32 s41, 933888
    buffer_load_dwordx4 v[164:167], v246, s[20:23], s41 offen sc1
    s_waitcnt lgkmcnt(8)
    v_mfma_f32_16x16x32_f16 v[80:83], v[176:179], v[192:195], v[80:83]
    v_cvt_pk_f16_f32 v232, v232, v233
    v_cvt_pk_f16_f32 v233, v234, v235
    v_mfma_f32_16x16x32_f16 v[84:87], v[180:183], v[192:195], v[84:87]
    ds_read_b128 v[192:195], v240 offset:0
    v_cvt_pk_f16_f32 v234, v236, v237
    s_waitcnt lgkmcnt(4)
    v_mfma_f32_16x16x32_f16 v[88:91], v[176:179], v[196:199], v[88:91]
    v_cvt_pk_f16_f32 v235, v238, v239
    ds_write_b128 v245, v[232:235] offset:43520
    v_mfma_f32_16x16x32_f16 v[92:95], v[180:183], v[196:199], v[92:95]
    ds_read_b128 v[196:199], v240 offset:1024
    s_mov_b32 s63, 950272
    buffer_load_dwordx4 v[168:171], v246, s[20:23], s63 offen sc1
    s_waitcnt lgkmcnt(5)
    v_mfma_f32_16x16x32_f16 v[112:115], v[184:187], v[200:203], v[112:115]
    v_mfma_f32_16x16x32_f16 v[116:119], v[188:191], v[200:203], v[116:119]
    ds_read_b128 v[200:203], v241 offset:2048
    s_waitcnt lgkmcnt(4)
    v_mfma_f32_16x16x32_f16 v[120:123], v[184:187], v[204:207], v[120:123]
    s_mov_b32 s41, 966656
    buffer_load_dwordx4 v[172:175], v246, s[20:23], s41 offen sc1
    v_mfma_f32_16x16x32_f16 v[124:127], v[188:191], v[204:207], v[124:127]
    ds_read_b128 v[204:207], v241 offset:3072
    s_waitcnt lgkmcnt(3)
    s_barrier
    s_bitcmp1_b32 s62, 6
    s_cbranch_scc1 L_RS6
L_RB6:
    s_waitcnt vmcnt(12)
    v_mfma_f32_16x16x32_f16 v[0:3], v[128:131], v[192:195], v[0:3]
    s_waitcnt vmcnt(11)
    v_mfma_f32_16x16x32_f16 v[4:7], v[132:135], v[192:195], v[4:7]
    ds_read_b128 v[192:195], v240 offset:4096
    v_mfma_f32_16x16x32_bf16 v[224:227], v[208:211], v[216:219], 0
    v_mfma_f32_16x16x32_bf16 v[232:235], v[208:211], v[220:223], 0
    ds_read_b64_tr_b16 v[208:209], v242 offset:60928
    v_mfma_f32_16x16x32_bf16 v[228:231], v[212:215], v[216:219], 0
    ds_read_b64_tr_b16 v[210:211], v242 offset:61184
    v_mfma_f32_16x16x32_bf16 v[236:239], v[212:215], v[220:223], 0
    ds_read_b64_tr_b16 v[212:213], v243 offset:60928
    s_waitcnt lgkmcnt(6)
    v_mfma_f32_16x16x32_f16 v[8:11], v[128:131], v[196:199], v[8:11]
    ds_read_b64_tr_b16 v[214:215], v243 offset:61184
    v_mfma_f32_16x16x32_f16 v[12:15], v[132:135], v[196:199], v[12:15]
    ds_read_b128 v[196:199], v240 offset:5120
    s_mov_b32 s63, 983040
    buffer_load_dwordx4 v[176:179], v246, s[20:23], s63 offen sc1
    s_waitcnt lgkmcnt(7)
    s_waitcnt vmcnt(11)
    v_mfma_f32_16x16x32_f16 v[32:35], v[136:139], v[200:203], v[32:35]
    v_cvt_pk_f16_f32 v224, v224, v225
    v_cvt_pk_f16_f32 v225, v226, v227
    s_waitcnt vmcnt(10)
    v_mfma_f32_16x16x32_f16 v[36:39], v[140:143], v[200:203], v[36:39]
    ds_read_b128 v[200:203], v241 offset:6144
    v_cvt_pk_f16_f32 v226, v228, v229
    s_waitcnt lgkmcnt(7)
    v_mfma_f32_16x16x32_f16 v[40:43], v[136:139], v[204:207], v[40:43]
    v_cvt_pk_f16_f32 v227, v230, v231
    ds_write_b128 v244, v[224:227] offset:16384
    v_mfma_f32_16x16x32_f16 v[44:47], v[140:143], v[204:207], v[44:47]
    ds_read_b128 v[204:207], v241 offset:7168
    s_mov_b32 s41, 999424
    buffer_load_dwordx4 v[180:183], v246, s[20:23], s41 offen sc1
    s_waitcnt lgkmcnt(8)
    s_waitcnt vmcnt(9)
    v_mfma_f32_16x16x32_f16 v[64:67], v[144:147], v[192:195], v[64:67]
    v_cvt_pk_f16_f32 v232, v232, v233
    v_cvt_pk_f16_f32 v233, v234, v235
    s_waitcnt vmcnt(8)
    v_mfma_f32_16x16x32_f16 v[68:71], v[148:151], v[192:195], v[68:71]
    ds_read_b128 v[192:195], v240 offset:8192
    v_cvt_pk_f16_f32 v234, v236, v237
    s_waitcnt lgkmcnt(4)
    v_mfma_f32_16x16x32_f16 v[72:75], v[144:147], v[196:199], v[72:75]
    v_cvt_pk_f16_f32 v235, v238, v239
    ds_write_b128 v245, v[232:235] offset:52224
    v_mfma_f32_16x16x32_f16 v[76:79], v[148:151], v[196:199], v[76:79]
    ds_read_b128 v[196:199], v240 offset:9216
    s_mov_b32 s63, 1015808
    buffer_load_dwordx4 v[184:187], v246, s[20:23], s63 offen sc1
    s_waitcnt lgkmcnt(5)
    s_waitcnt vmcnt(8)
    v_mfma_f32_16x16x32_f16 v[96:99], v[152:155], v[200:203], v[96:99]
    s_waitcnt vmcnt(7)
    v_mfma_f32_16x16x32_f16 v[100:103], v[156:159], v[200:203], v[100:103]
    ds_read_b128 v[200:203], v241 offset:10240
    s_waitcnt lgkmcnt(4)
    v_mfma_f32_16x16x32_f16 v[104:107], v[152:155], v[204:207], v[104:107]
    s_mov_b32 s41, 1032192
    buffer_load_dwordx4 v[188:191], v246, s[20:23], s41 offen sc1
    v_mfma_f32_16x16x32_f16 v[108:111], v[156:159], v[204:207], v[108:111]
    ds_read_b128 v[204:207], v241 offset:11264
    s_mov_b32 s44, 0
L_CHK:
    v_cmp_eq_u32 vcc, 0, v252
    s_cbranch_vccz L_CHKOK
    buffer_load_dword v252, v253, s[24:27], 0 offen offset:128 sc1
    s_add_u32 s44, s44, 1
    s_waitcnt vmcnt(0)
    s_cmp_lt_u32 s44, 100000
    s_cbranch_scc1 L_CHK
L_CHKOK:
    s_waitcnt lgkmcnt(3)
    s_barrier
    v_mfma_f32_16x16x32_f16 v[16:19], v[128:131], v[192:195], v[16:19]
    v_mfma_f32_16x16x32_f16 v[20:23], v[132:135], v[192:195], v[20:23]
    ds_read_b128 v[192:195], v240 offset:12288
    v_mfma_f32_16x16x32_bf16 v[224:227], v[208:211], v[216:219], 0
    v_mfma_f32_16x16x32_bf16 v[232:235], v[208:211], v[220:223], 0
    v_mfma_f32_16x16x32_bf16 v[228:231], v[212:215], v[216:219], 0
    v_mfma_f32_16x16x32_bf16 v[236:239], v[212:215], v[220:223], 0
    s_waitcnt lgkmcnt(3)
    v_mfma_f32_16x16x32_f16 v[24:27], v[128:131], v[196:199], v[24:27]
    v_mfma_f32_16x16x32_f16 v[28:31], v[132:135], v[196:199], v[28:31]
    ds_read_b128 v[196:199], v240 offset:13312
    s_mov_b32 s63, 1048576
    buffer_load_dwordx4 v[128:131], v246, s[20:23], s63 offen sc1
    s_waitcnt lgkmcnt(3)
    v_mfma_f32_16x16x32_f16 v[48:51], v[136:139], v[200:203], v[48:51]
    v_cvt_pk_f16_f32 v224, v224, v225
    v_cvt_pk_f16_f32 v225, v226, v227
    v_mfma_f32_16x16x32_f16 v[52:55], v[140:143], v[200:203], v[52:55]
    ds_read_b128 v[200:203], v241 offset:14336
    v_cvt_pk_f16_f32 v226, v228, v229
    s_waitcnt lgkmcnt(3)
    v_mfma_f32_16x16x32_f16 v[56:59], v[136:139], v[204:207], v[56:59]
    v_cvt_pk_f16_f32 v227, v230, v231
    ds_write_b128 v244, v[224:227] offset:0
    v_mfma_f32_16x16x32_f16 v[60:63], v[140:143], v[204:207], v[60:63]
    ds_read_b128 v[204:207], v241 offset:15360
    s_mov_b32 s41, 1064960
    buffer_load_dwordx4 v[132:135], v246, s[20:23], s41 offen sc1
    s_waitcnt lgkmcnt(4)
    v_mfma_f32_16x16x32_f16 v[80:83], v[144:147], v[192:195], v[80:83]
    v_cvt_pk_f16_f32 v232, v232, v233
    v_cvt_pk_f16_f32 v233, v234, v235
    v_mfma_f32_16x16x32_f16 v[84:87], v[148:151], v[192:195], v[84:87]
    ds_read_b128 v[192:195], v240 offset:16384
    v_cvt_pk_f16_f32 v234, v236, v237
    s_waitcnt lgkmcnt(4)
    v_mfma_f32_16x16x32_f16 v[88:91], v[144:147], v[196:199], v[88:91]
    v_cvt_pk_f16_f32 v235, v238, v239
    ds_write_b128 v245, v[232:235] offset:60928
    v_mfma_f32_16x16x32_f16 v[92:95], v[148:151], v[196:199], v[92:95]
    ds_read_b128 v[196:199], v240 offset:17408
    s_mov_b32 s63, 1081344
    buffer_load_dwordx4 v[136:139], v246, s[20:23], s63 offen sc1
    s_waitcnt lgkmcnt(5)
    v_mfma_f32_16x16x32_f16 v[112:115], v[152:155], v[200:203], v[112:115]
    v_mfma_f32_16x16x32_f16 v[116:119], v[156:159], v[200:203], v[116:119]
    ds_read_b128 v[200:203], v241 offset:18432
    s_waitcnt lgkmcnt(4)
    v_mfma_f32_16x16x32_f16 v[120:123], v[152:155], v[204:207], v[120:123]
    s_mov_b32 s41, 1097728
    buffer_load_dwordx4 v[140:143], v246, s[20:23], s41 offen sc1
    v_mfma_f32_16x16x32_f16 v[124:127], v[156:159], v[204:207], v[124:127]
    ds_read_b128 v[204:207], v241 offset:19456
    s_waitcnt lgkmcnt(3)
    s_barrier
    s_bitcmp1_b32 s62, 7
    s_cbranch_scc1 L_RS7
L_RB7:
    s_waitcnt vmcnt(11)
    v_mfma_f32_16x16x32_f16 v[0:3], v[160:163], v[192:195], v[0:3]
    s_waitcnt vmcnt(10)
    v_mfma_f32_16x16x32_f16 v[4:7], v[164:167], v[192:195], v[4:7]
    ds_read_b128 v[192:195], v240 offset:20480
    s_waitcnt lgkmcnt(3)
    v_mfma_f32_16x16x32_f16 v[8:11], v[160:163], v[196:199], v[8:11]
    v_mfma_f32_16x16x32_f16 v[12:15], v[164:167], v[196:199], v[12:15]
    ds_read_b128 v[196:199], v240 offset:21504
    s_waitcnt lgkmcnt(3)
    s_waitcnt vmcnt(9)
    v_mfma_f32_16x16x32_f16 v[32:35], v[168:171], v[200:203], v[32:35]
    s_mov_b32 s63, 1114112
    buffer_load_dwordx4 v[144:147], v246, s[20:23], s63 offen sc1
    s_waitcnt vmcnt(9)
    v_mfma_f32_16x16x32_f16 v[36:39], v[172:175], v[200:203], v[36:39]
    ds_read_b128 v[200:203], v241 offset:22528
    s_waitcnt lgkmcnt(3)
    v_mfma_f32_16x16x32_f16 v[40:43], v[168:171], v[204:207], v[40:43]
    s_mov_b32 s41, 1130496
    buffer_load_dwordx4 v[148:151], v246, s[20:23], s41 offen sc1
    v_mfma_f32_16x16x32_f16 v[44:47], v[172:175], v[204:207], v[44:47]
    ds_read_b128 v[204:207], v241 offset:23552
    s_waitcnt lgkmcnt(3)
    s_waitcnt vmcnt(9)
    v_mfma_f32_16x16x32_f16 v[64:67], v[176:179], v[192:195], v[64:67]
    s_waitcnt vmcnt(8)
    v_mfma_f32_16x16x32_f16 v[68:71], v[180:183], v[192:195], v[68:71]
    ds_read_b128 v[192:195], v240 offset:0
    s_waitcnt lgkmcnt(3)
    v_mfma_f32_16x16x32_f16 v[72:75], v[176:179], v[196:199], v[72:75]
    s_mov_b32 s63, 1146880
    buffer_load_dwordx4 v[152:155], v246, s[20:23], s63 offen sc1
    v_mfma_f32_16x16x32_f16 v[76:79], v[180:183], v[196:199], v[76:79]
    ds_read_b128 v[196:199], v240 offset:1024
    s_waitcnt lgkmcnt(3)
    s_waitcnt vmcnt(8)
    v_mfma_f32_16x16x32_f16 v[96:99], v[184:187], v[200:203], v[96:99]
    s_waitcnt vmcnt(7)
    v_mfma_f32_16x16x32_f16 v[100:103], v[188:191], v[200:203], v[100:103]
    ds_read_b128 v[200:203], v241 offset:2048
    s_waitcnt lgkmcnt(3)
    v_mfma_f32_16x16x32_f16 v[104:107], v[184:187], v[204:207], v[104:107]
    s_mov_b32 s41, 1163264
    buffer_load_dwordx4 v[156:159], v246, s[20:23], s41 offen sc1
    v_mfma_f32_16x16x32_f16 v[108:111], v[188:191], v[204:207], v[108:111]
    ds_read_b128 v[204:207], v241 offset:3072
    s_waitcnt lgkmcnt(3)
    v_lshrrev_b32 v252, 1, v249
    v_lshlrev_b32 v222, 8, v252
    v_lshl_add_u32 v222, v248, 4, v222
    v_and_b32 v252, 1, v249
    v_lshl_add_u32 v222, v252, 3, v222
    s_lshl_b32 s44, s28, 9
    v_add_u32 v222, s44, v222
    v_lshrrev_b32 v252, 1, v248
    v_lshlrev_b32 v223, 12, v252
    v_and_b32 v252, 1, v248
    v_lshl_add_u32 v223, v252, 9, v223
    v_lshl_add_u32 v223, v249, 4, v223
    s_lshl_b32 s44, s28, 6
    s_add_u32 s44, s44, s38
    v_add_u32 v223, s44, v223
    s_barrier
    v_mfma_f32_16x16x32_f16 v[16:19], v[160:163], v[192:195], v[16:19]
    v_add_f32 v224, v0, v32
    v_sub_f32 v225, v0, v32
    v_add_f32 v0, v64, v96
    v_sub_f32 v32, v64, v96
    v_fma_f32 v64, -4.0, v0, v224
    v_sub_f32 v96, v225, v32
    v_add_f32 v224, v224, v0
    v_fmac_f32 v225, 4.0, v32
    v_fma_f32 v0, 0.5, v225, v224
    v_fma_f32 v32, -0.5, v225, v224
    v_mfma_f32_16x16x32_f16 v[20:23], v[164:167], v[192:195], v[20:23]
    ds_read_b128 v[192:195], v240 offset:4096
    v_add_f32 v226, v1, v33
    v_sub_f32 v227, v1, v33
    v_add_f32 v1, v65, v97
    v_sub_f32 v33, v65, v97
    v_fma_f32 v65, -4.0, v1, v226
    v_sub_f32 v97, v227, v33
    v_add_f32 v226, v226, v1
    v_fmac_f32 v227, 4.0, v33
    v_fma_f32 v1, 0.5, v227, v226
    v_fma_f32 v33, -0.5, v227, v226
    s_waitcnt lgkmcnt(3)
    v_mfma_f32_16x16x32_f16 v[24:27], v[160:163], v[196:199], v[24:27]
    v_add_f32 v228, v2, v34
    v_sub_f32 v229, v2, v34
    v_add_f32 v2, v66, v98
    v_sub_f32 v34, v66, v98
    v_fma_f32 v66, -4.0, v2, v228
    v_sub_f32 v98, v229, v34
    v_add_f32 v228, v228, v2
    v_fmac_f32 v229, 4.0, v34
    v_fma_f32 v2, 0.5, v229, v228
    v_fma_f32 v34, -0.5, v229, v228
    v_mfma_f32_16x16x32_f16 v[28:31], v[164:167], v[196:199], v[28:31]
    ds_read_b128 v[196:199], v240 offset:5120
    v_add_f32 v230, v3, v35
    v_sub_f32 v231, v3, v35
    v_add_f32 v3, v67, v99
    v_sub_f32 v35, v67, v99
    v_fma_f32 v67, -4.0, v3, v230
    v_sub_f32 v99, v231, v35
    v_add_f32 v230, v230, v3
    v_fmac_f32 v231, 4.0, v35
    v_fma_f32 v3, 0.5, v231, v230
    v_fma_f32 v35, -0.5, v231, v230
    s_waitcnt lgkmcnt(3)
    v_mfma_f32_16x16x32_f16 v[48:51], v[168:171], v[200:203], v[48:51]
    s_mov_b32 s63, 1179648
    buffer_load_dwordx4 v[160:163], v246, s[20:23], s63 offen sc1
    v_add_f32 v224, v4, v36
    v_sub_f32 v225, v4, v36
    v_add_f32 v4, v68, v100
    v_sub_f32 v36, v68, v100
    v_fma_f32 v68, -4.0, v4, v224
    v_sub_f32 v100, v225, v36
    v_add_f32 v224, v224, v4
    v_fmac_f32 v225, 4.0, v36
    v_fma_f32 v4, 0.5, v225, v224
    v_fma_f32 v36, -0.5, v225, v224
    v_mfma_f32_16x16x32_f16 v[52:55], v[172:175], v[200:203], v[52:55]
    ds_read_b128 v[200:203], v241 offset:6144
    v_add_f32 v226, v5, v37
    v_sub_f32 v227, v5, v37
    v_add_f32 v5, v69, v101
    v_sub_f32 v37, v69, v101
    v_fma_f32 v69, -4.0, v5, v226
    v_sub_f32 v101, v227, v37
    v_add_f32 v226, v226, v5
    v_fmac_f32 v227, 4.0, v37
    v_fma_f32 v5, 0.5, v227, v226
    v_fma_f32 v37, -0.5, v227, v226
    s_waitcnt lgkmcnt(3)
    v_mfma_f32_16x16x32_f16 v[56:59], v[168:171], v[204:207], v[56:59]
    s_mov_b32 s41, 1196032
    buffer_load_dwordx4 v[164:167], v246, s[20:23], s41 offen sc1
    v_add_f32 v228, v6, v38
    v_sub_f32 v229, v6, v38
    v_add_f32 v6, v70, v102
    v_sub_f32 v38, v70, v102
    v_fma_f32 v70, -4.0, v6, v228
    v_sub_f32 v102, v229, v38
    v_add_f32 v228, v228, v6
    v_fmac_f32 v229, 4.0, v38
    v_fma_f32 v6, 0.5, v229, v228
    v_fma_f32 v38, -0.5, v229, v228
    v_mfma_f32_16x16x32_f16 v[60:63], v[172:175], v[204:207], v[60:63]
    ds_read_b128 v[204:207], v241 offset:7168
    v_add_f32 v230, v7, v39
    v_sub_f32 v231, v7, v39
    v_add_f32 v7, v71, v103
    v_sub_f32 v39, v71, v103
    v_fma_f32 v71, -4.0, v7, v230
    v_sub_f32 v103, v231, v39
    v_add_f32 v230, v230, v7
    v_fmac_f32 v231, 4.0, v39
    v_fma_f32 v7, 0.5, v231, v230
    v_fma_f32 v39, -0.5, v231, v230
    s_waitcnt lgkmcnt(3)
    v_mfma_f32_16x16x32_f16 v[80:83], v[176:179], v[192:195], v[80:83]
    v_add_f32 v224, v8, v40
    v_sub_f32 v225, v8, v40
    v_add_f32 v8, v72, v104
    v_sub_f32 v40, v72, v104
    v_fma_f32 v72, -4.0, v8, v224
    v_sub_f32 v104, v225, v40
    v_add_f32 v224, v224, v8
    v_fmac_f32 v225, 4.0, v40
    v_fma_f32 v8, 0.5, v225, v224
    v_fma_f32 v40, -0.5, v225, v224
    v_mfma_f32_16x16x32_f16 v[84:87], v[180:183], v[192:195], v[84:87]
    v_add_u32 v240, 4294828032, v240
    ds_read_b128 v[192:195], v240 offset:0
    v_add_f32 v226, v9, v41
    v_sub_f32 v227, v9, v41
    v_add_f32 v9, v73, v105
    v_sub_f32 v41, v73, v105
    v_fma_f32 v73, -4.0, v9, v226
    v_sub_f32 v105, v227, v41
    v_add_f32 v226, v226, v9
    v_fmac_f32 v227, 4.0, v41
    v_fma_f32 v9, 0.5, v227, v226
    v_fma_f32 v41, -0.5, v227, v226
    s_waitcnt lgkmcnt(3)
    v_mfma_f32_16x16x32_f16 v[88:91], v[176:179], v[196:199], v[88:91]
    s_mov_b32 s63, 1212416
    buffer_load_dwordx4 v[168:171], v246, s[20:23], s63 offen sc1
    v_add_f32 v228, v10, v42
    v_sub_f32 v229, v10, v42
    v_add_f32 v10, v74, v106
    v_sub_f32 v42, v74, v106
    v_fma_f32 v74, -4.0, v10, v228
    v_sub_f32 v106, v229, v42
    v_add_f32 v228, v228, v10
    v_fmac_f32 v229, 4.0, v42
    v_fma_f32 v10, 0.5, v229, v228
    v_fma_f32 v42, -0.5, v229, v228
    v_mfma_f32_16x16x32_f16 v[92:95], v[180:183], v[196:199], v[92:95]
    ds_read_b128 v[196:199], v240 offset:1024
    v_add_f32 v230, v11, v43
    v_sub_f32 v231, v11, v43
    v_add_f32 v11, v75, v107
    v_sub_f32 v43, v75, v107
    v_fma_f32 v75, -4.0, v11, v230
    v_sub_f32 v107, v231, v43
    v_add_f32 v230, v230, v11
    v_fmac_f32 v231, 4.0, v43
    v_fma_f32 v11, 0.5, v231, v230
    v_fma_f32 v43, -0.5, v231, v230
    s_waitcnt lgkmcnt(3)
    v_mfma_f32_16x16x32_f16 v[112:115], v[184:187], v[200:203], v[112:115]
    v_add_f32 v224, v12, v44
    v_sub_f32 v225, v12, v44
    v_add_f32 v12, v76, v108
    v_sub_f32 v44, v76, v108
    v_fma_f32 v76, -4.0, v12, v224
    v_sub_f32 v108, v225, v44
    v_add_f32 v224, v224, v12
    v_fmac_f32 v225, 4.0, v44
    v_fma_f32 v12, 0.5, v225, v224
    v_fma_f32 v44, -0.5, v225, v224
    v_mfma_f32_16x16x32_f16 v[116:119], v[188:191], v[200:203], v[116:119]
    v_add_u32 v241, 4294830080, v241
    ds_read_b128 v[200:203], v241 offset:0
    v_add_f32 v226, v13, v45
    v_sub_f32 v227, v13, v45
    v_add_f32 v13, v77, v109
    v_sub_f32 v45, v77, v109
    v_fma_f32 v77, -4.0, v13, v226
    v_sub_f32 v109, v227, v45
    v_add_f32 v226, v226, v13
    v_fmac_f32 v227, 4.0, v45
    v_fma_f32 v13, 0.5, v227, v226
    v_fma_f32 v45, -0.5, v227, v226
    s_waitcnt lgkmcnt(3)
    v_mfma_f32_16x16x32_f16 v[120:123], v[184:187], v[204:207], v[120:123]
    s_mov_b32 s41, 1228800
    buffer_load_dwordx4 v[172:175], v246, s[20:23], s41 offen sc1
    v_add_f32 v228, v14, v46
    v_sub_f32 v229, v14, v46
    v_add_f32 v14, v78, v110
    v_sub_f32 v46, v78, v110
    v_fma_f32 v78, -4.0, v14, v228
    v_sub_f32 v110, v229, v46
    v_add_f32 v228, v228, v14
    v_fmac_f32 v229, 4.0, v46
    v_fma_f32 v14, 0.5, v229, v228
    v_fma_f32 v46, -0.5, v229, v228
    v_mfma_f32_16x16x32_f16 v[124:127], v[188:191], v[204:207], v[124:127]
    ds_read_b128 v[204:207], v241 offset:1024
    v_add_f32 v230, v15, v47
    v_sub_f32 v231, v15, v47
    v_add_f32 v15, v79, v111
    v_sub_f32 v47, v79, v111
    v_fma_f32 v79, -4.0, v15, v230
    v_sub_f32 v111, v231, v47
    v_add_f32 v230, v230, v15
    v_fmac_f32 v231, 4.0, v47
    v_fma_f32 v15, 0.5, v231, v230
    v_fma_f32 v47, -0.5, v231, v230
    s_bitcmp1_b32 s62, 0
    s_cbranch_scc1 L_RS8
L_RB8:
    s_waitcnt lgkmcnt(3)
    s_waitcnt vmcnt(11)
    v_mfma_f32_16x16x32_f16 v[0:3], v[128:131], v[192:195], v[0:3]
    v_add_f32 v224, v16, v48
    v_sub_f32 v225, v16, v48
    v_add_f32 v16, v80, v112
    v_sub_f32 v48, v80, v112
    v_fma_f32 v80, -4.0, v16, v224
    v_sub_f32 v112, v225, v48
    v_add_f32 v224, v224, v16
    v_fmac_f32 v225, 4.0, v48
    v_fma_f32 v16, 0.5, v225, v224
    v_fma_f32 v48, -0.5, v225, v224
    s_waitcnt vmcnt(10)
    v_mfma_f32_16x16x32_f16 v[4:7], v[132:135], v[192:195], v[4:7]
    ds_read_b128 v[192:195], v240 offset:4096
    v_add_f32 v226, v17, v49
    v_sub_f32 v227, v17, v49
    v_add_f32 v17, v81, v113
    v_sub_f32 v49, v81, v113
    v_fma_f32 v81, -4.0, v17, v226
    v_sub_f32 v113, v227, v49
    v_add_f32 v226, v226, v17
    v_fmac_f32 v227, 4.0, v49
    v_fma_f32 v17, 0.5, v227, v226
    v_fma_f32 v49, -0.5, v227, v226
    s_waitcnt lgkmcnt(3)
    v_mfma_f32_16x16x32_f16 v[8:11], v[128:131], v[196:199], v[8:11]
    v_add_f32 v228, v18, v50
    v_sub_f32 v229, v18, v50
    v_add_f32 v18, v82, v114
    v_sub_f32 v50, v82, v114
    v_fma_f32 v82, -4.0, v18, v228
    v_sub_f32 v114, v229, v50
    v_add_f32 v228, v228, v18
    v_fmac_f32 v229, 4.0, v50
    v_fma_f32 v18, 0.5, v229, v228
    v_fma_f32 v50, -0.5, v229, v228
    v_mfma_f32_16x16x32_f16 v[12:15], v[132:135], v[196:199], v[12:15]
    ds_read_b128 v[196:199], v240 offset:5120
    v_add_f32 v230, v19, v51
    v_sub_f32 v231, v19, v51
    v_add_f32 v19, v83, v115
    v_sub_f32 v51, v83, v115
    v_fma_f32 v83, -4.0, v19, v230
    v_sub_f32 v115, v231, v51
    v_add_f32 v230, v230, v19
    v_fmac_f32 v231, 4.0, v51
    v_fma_f32 v19, 0.5, v231, v230
    v_fma_f32 v51, -0.5, v231, v230
    s_waitcnt lgkmcnt(3)
    s_waitcnt vmcnt(9)
    v_mfma_f32_16x16x32_f16 v[32:35], v[136:139], v[200:203], v[32:35]
    s_mov_b32 s63, 1245184
    buffer_load_dwordx4 v[176:179], v246, s[20:23], s63 offen sc1
    v_add_f32 v224, v20, v52
    v_sub_f32 v225, v20, v52
    v_add_f32 v20, v84, v116
    v_sub_f32 v52, v84, v116
    v_fma_f32 v84, -4.0, v20, v224
    v_sub_f32 v116, v225, v52
    v_add_f32 v224, v224, v20
    v_fmac_f32 v225, 4.0, v52
    v_fma_f32 v20, 0.5, v225, v224
    v_fma_f32 v52, -0.5, v225, v224
    s_waitcnt vmcnt(9)
    v_mfma_f32_16x16x32_f16 v[36:39], v[140:143], v[200:203], v[36:39]
    ds_read_b128 v[200:203], v241 offset:4096
    v_add_f32 v226, v21, v53
    v_sub_f32 v227, v21, v53
    v_add_f32 v21, v85, v117
    v_sub_f32 v53, v85, v117
    v_fma_f32 v85, -4.0, v21, v226
    v_sub_f32 v117, v227, v53
    v_add_f32 v226, v226, v21
    v_fmac_f32 v227, 4.0, v53
    v_fma_f32 v21, 0.5, v227, v226
    v_fma_f32 v53, -0.5, v227, v226
    s_waitcnt lgkmcnt(3)
    v_mfma_f32_16x16x32_f16 v[40:43], v[136:139], v[204:207], v[40:43]
    s_mov_b32 s41, 1261568
    buffer_load_dwordx4 v[180:183], v246, s[20:23], s41 offen sc1
    v_add_f32 v228, v22, v54
    v_sub_f32 v229, v22, v54
    v_add_f32 v22, v86, v118
    v_sub_f32 v54, v86, v118
    v_fma_f32 v86, -4.0, v22, v228
    v_sub_f32 v118, v229, v54
    v_add_f32 v228, v228, v22
    v_fmac_f32 v229, 4.0, v54
    v_fma_f32 v22, 0.5, v229, v228
    v_fma_f32 v54, -0.5, v229, v228
    v_mfma_f32_16x16x32_f16 v[44:47], v[140:143], v[204:207], v[44:47]
    ds_read_b128 v[204:207], v241 offset:5120
    v_add_f32 v230, v23, v55
    v_sub_f32 v231, v23, v55
    v_add_f32 v23, v87, v119
    v_sub_f32 v55, v87, v119
    v_fma_f32 v87, -4.0, v23, v230
    v_sub_f32 v119, v231, v55
    v_add_f32 v230, v230, v23
    v_fmac_f32 v231, 4.0, v55
    v_fma_f32 v23, 0.5, v231, v230
    v_fma_f32 v55, -0.5, v231, v230
    s_waitcnt lgkmcnt(3)
    s_waitcnt vmcnt(9)
    v_mfma_f32_16x16x32_f16 v[64:67], v[144:147], v[192:195], v[64:67]
    v_add_f32 v224, v24, v56
    v_sub_f32 v225, v24, v56
    v_add_f32 v24, v88, v120
    v_sub_f32 v56, v88, v120
    v_fma_f32 v88, -4.0, v24, v224
    v_sub_f32 v120, v225, v56
    v_add_f32 v224, v224, v24
    v_fmac_f32 v225, 4.0, v56
    v_fma_f32 v24, 0.5, v225, v224
    v_fma_f32 v56, -0.5, v225, v224
    s_waitcnt vmcnt(8)
    v_mfma_f32_16x16x32_f16 v[68:71], v[148:151], v[192:195], v[68:71]
    ds_read_b128 v[192:195], v240 offset:8704
    v_add_f32 v226, v25, v57
    v_sub_f32 v227, v25, v57
    v_add_f32 v25, v89, v121
    v_sub_f32 v57, v89, v121
    v_fma_f32 v89, -4.0, v25, v226
    v_sub_f32 v121, v227, v57
    v_add_f32 v226, v226, v25
    v_fmac_f32 v227, 4.0, v57
    v_fma_f32 v25, 0.5, v227, v226
    v_fma_f32 v57, -0.5, v227, v226
    s_waitcnt lgkmcnt(3)
    v_mfma_f32_16x16x32_f16 v[72:75], v[144:147], v[196:199], v[72:75]
    s_mov_b32 s63, 1277952
    buffer_load_dwordx4 v[184:187], v246, s[20:23], s63 offen sc1
    v_add_f32 v228, v26, v58
    v_sub_f32 v229, v26, v58
    v_add_f32 v26, v90, v122
    v_sub_f32 v58, v90, v122
    v_fma_f32 v90, -4.0, v26, v228
    v_sub_f32 v122, v229, v58
    v_add_f32 v228, v228, v26
    v_fmac_f32 v229, 4.0, v58
    v_fma_f32 v26, 0.5, v229, v228
    v_fma_f32 v58, -0.5, v229, v228
    v_mfma_f32_16x16x32_f16 v[76:79], v[148:151], v[196:199], v[76:79]
    ds_read_b128 v[196:199], v240 offset:9728
    v_add_f32 v230, v27, v59
    v_sub_f32 v231, v27, v59
    v_add_f32 v27, v91, v123
    v_sub_f32 v59, v91, v123
    v_fma_f32 v91, -4.0, v27, v230
    v_sub_f32 v123, v231, v59
    v_add_f32 v230, v230, v27
    v_fmac_f32 v231, 4.0, v59
    v_fma_f32 v27, 0.5, v231, v230
    v_fma_f32 v59, -0.5, v231, v230
    s_waitcnt lgkmcnt(3)
    s_waitcnt vmcnt(8)
    v_mfma_f32_16x16x32_f16 v[96:99], v[152:155], v[200:203], v[96:99]
    v_add_f32 v224, v28, v60
    v_sub_f32 v225, v28, v60
    v_add_f32 v28, v92, v124
    v_sub_f32 v60, v92, v124
    v_fma_f32 v92, -4.0, v28, v224
    v_sub_f32 v124, v225, v60
    v_add_f32 v224, v224, v28
    v_fmac_f32 v225, 4.0, v60
    v_fma_f32 v28, 0.5, v225, v224
    v_fma_f32 v60, -0.5, v225, v224
    s_waitcnt vmcnt(7)
    v_mfma_f32_16x16x32_f16 v[100:103], v[156:159], v[200:203], v[100:103]
    ds_read_b128 v[200:203], v241 offset:8704
    v_add_f32 v226, v29, v61
    v_sub_f32 v227, v29, v61
    v_add_f32 v29, v93, v125
    v_sub_f32 v61, v93, v125
    v_fma_f32 v93, -4.0, v29, v226
    v_sub_f32 v125, v227, v61
    v_add_f32 v226, v226, v29
    v_fmac_f32 v227, 4.0, v61
    v_fma_f32 v29, 0.5, v227, v226
    v_fma_f32 v61, -0.5, v227, v226
    s_waitcnt lgkmcnt(3)
    v_mfma_f32_16x16x32_f16 v[104:107], v[152:155], v[204:207], v[104:107]
    s_mov_b32 s41, 1294336
    buffer_load_dwordx4 v[188:191], v246, s[20:23], s41 offen sc1
    v_add_f32 v228, v30, v62
    v_sub_f32 v229, v30, v62
    v_add_f32 v30, v94, v126
    v_sub_f32 v62, v94, v126
    v_fma_f32 v94, -4.0, v30, v228
    v_sub_f32 v126, v229, v62
    v_add_f32 v228, v228, v30
    v_fmac_f32 v229, 4.0, v62
    v_fma_f32 v30, 0.5, v229, v228
    v_fma_f32 v62, -0.5, v229, v228
    v_mfma_f32_16x16x32_f16 v[108:111], v[156:159], v[204:207], v[108:111]
    ds_read_b128 v[204:207], v241 offset:9728
    v_add_f32 v230, v31, v63
    v_sub_f32 v231, v31, v63
    v_add_f32 v31, v95, v127
    v_sub_f32 v63, v95, v127
    v_fma_f32 v95, -4.0, v31, v230
    v_sub_f32 v127, v231, v63
    v_add_f32 v230, v230, v31
    v_fmac_f32 v231, 4.0, v63
    v_fma_f32 v31, 0.5, v231, v230
    v_fma_f32 v63, -0.5, v231, v230
    s_waitcnt lgkmcnt(3)
    v_mfma_f32_16x16x32_f16 v[16:19], v[128:131], v[192:195], v[16:19]
    v_mfma_f32_16x16x32_f16 v[20:23], v[132:135], v[192:195], v[20:23]
    ds_read_b128 v[192:195], v240 offset:12800
    s_waitcnt lgkmcnt(3)
    v_mfma_f32_16x16x32_f16 v[24:27], v[128:131], v[196:199], v[24:27]
    v_mfma_f32_16x16x32_f16 v[28:31], v[132:135], v[196:199], v[28:31]
    ds_read_b128 v[196:199], v240 offset:13824
    s_waitcnt lgkmcnt(3)
    v_mfma_f32_16x16x32_f16 v[48:51], v[136:139], v[200:203], v[48:51]
    s_mov_b32 s63, 1310720
    buffer_load_dwordx4 v[128:131], v246, s[20:23], s63 offen sc1
    v_mfma_f32_16x16x32_f16 v[52:55], v[140:143], v[200:203], v[52:55]
    ds_read_b128 v[200:203], v241 offset:12800
    s_waitcnt lgkmcnt(3)
    v_mfma_f32_16x16x32_f16 v[56:59], v[136:139], v[204:207], v[56:59]
    s_mov_b32 s41, 1327104
    buffer_load_dwordx4 v[132:135], v246, s[20:23], s41 offen sc1
    v_mfma_f32_16x16x32_f16 v[60:63], v[140:143], v[204:207], v[60:63]
    ds_read_b128 v[204:207], v241 offset:13824
    s_waitcnt lgkmcnt(3)
    v_mfma_f32_16x16x32_f16 v[80:83], v[144:147], v[192:195], v[80:83]
    v_mfma_f32_16x16x32_f16 v[84:87], v[148:151], v[192:195], v[84:87]
    ds_read_b128 v[192:195], v240 offset:17408
    s_waitcnt lgkmcnt(3)
    v_mfma_f32_16x16x32_f16 v[88:91], v[144:147], v[196:199], v[88:91]
    s_mov_b32 s63, 1343488
    buffer_load_dwordx4 v[136:139], v246, s[20:23], s63 offen sc1
    v_mfma_f32_16x16x32_f16 v[92:95], v[148:151], v[196:199], v[92:95]
    ds_read_b128 v[196:199], v240 offset:18432
    s_waitcnt lgkmcnt(3)
    v_mfma_f32_16x16x32_f16 v[112:115], v[152:155], v[200:203], v[112:115]
    v_mfma_f32_16x16x32_f16 v[116:119], v[156:159], v[200:203], v[116:119]
    ds_read_b128 v[200:203], v241 offset:17408
    s_waitcnt lgkmcnt(3)
    v_mfma_f32_16x16x32_f16 v[120:123], v[152:155], v[204:207], v[120:123]
    s_mov_b32 s41, 1359872
    buffer_load_dwordx4 v[140:143], v246, s[20:23], s41 offen sc1
    v_mfma_f32_16x16x32_f16 v[124:127], v[156:159], v[204:207], v[124:127]
    ds_read_b128 v[204:207], v241 offset:18432
    s_bitcmp1_b32 s62, 1
    s_cbranch_scc1 L_RS9
L_RB9:
    s_waitcnt lgkmcnt(3)
    s_waitcnt vmcnt(11)
    v_mfma_f32_16x16x32_f16 v[0:3], v[160:163], v[192:195], v[0:3]
    s_waitcnt vmcnt(10)
    v_mfma_f32_16x16x32_f16 v[4:7], v[164:167], v[192:195], v[4:7]
    ds_read_b128 v[192:195], v240 offset:21504
    s_waitcnt lgkmcnt(3)
    v_mfma_f32_16x16x32_f16 v[8:11], v[160:163], v[196:199], v[8:11]
    v_mfma_f32_16x16x32_f16 v[12:15], v[164:167], v[196:199], v[12:15]
    ds_read_b128 v[196:199], v240 offset:22528
    s_waitcnt lgkmcnt(3)
    s_waitcnt vmcnt(9)
    v_mfma_f32_16x16x32_f16 v[32:35], v[168:171], v[200:203], v[32:35]
    s_mov_b32 s63, 1376256
    buffer_load_dwordx4 v[144:147], v246, s[20:23], s63 offen sc1
    s_waitcnt vmcnt(9)
    v_mfma_f32_16x16x32_f16 v[36:39], v[172:175], v[200:203], v[36:39]
    ds_read_b128 v[200:203], v241 offset:21504
    s_waitcnt lgkmcnt(3)
    v_mfma_f32_16x16x32_f16 v[40:43], v[168:171], v[204:207], v[40:43]
    s_mov_b32 s41, 1392640
    buffer_load_dwordx4 v[148:151], v246, s[20:23], s41 offen sc1
    v_mfma_f32_16x16x32_f16 v[44:47], v[172:175], v[204:207], v[44:47]
    ds_read_b128 v[204:207], v241 offset:22528
    s_waitcnt lgkmcnt(3)
    s_waitcnt vmcnt(9)
    v_mfma_f32_16x16x32_f16 v[64:67], v[176:179], v[192:195], v[64:67]
    s_waitcnt vmcnt(8)
    v_mfma_f32_16x16x32_f16 v[68:71], v[180:183], v[192:195], v[68:71]
    ds_read_b128 v[192:195], v240 offset:26112
    s_waitcnt lgkmcnt(3)
    v_mfma_f32_16x16x32_f16 v[72:75], v[176:179], v[196:199], v[72:75]
    s_mov_b32 s63, 1409024
    buffer_load_dwordx4 v[152:155], v246, s[20:23], s63 offen sc1
    v_mfma_f32_16x16x32_f16 v[76:79], v[180:183], v[196:199], v[76:79]
    ds_read_b128 v[196:199], v240 offset:27136
    s_waitcnt lgkmcnt(3)
    s_waitcnt vmcnt(8)
    v_mfma_f32_16x16x32_f16 v[96:99], v[184:187], v[200:203], v[96:99]
    s_waitcnt vmcnt(7)
    v_mfma_f32_16x16x32_f16 v[100:103], v[188:191], v[200:203], v[100:103]
    ds_read_b128 v[200:203], v241 offset:26112
    s_waitcnt lgkmcnt(3)
    v_mfma_f32_16x16x32_f16 v[104:107], v[184:187], v[204:207], v[104:107]
    s_mov_b32 s41, 1425408
    buffer_load_dwordx4 v[156:159], v246, s[20:23], s41 offen sc1
    v_mfma_f32_16x16x32_f16 v[108:111], v[188:191], v[204:207], v[108:111]
    ds_read_b128 v[204:207], v241 offset:27136
    s_waitcnt lgkmcnt(3)
    v_mfma_f32_16x16x32_f16 v[16:19], v[160:163], v[192:195], v[16:19]
    v_mfma_f32_16x16x32_f16 v[20:23], v[164:167], v[192:195], v[20:23]
    ds_read_b128 v[192:195], v240 offset:30208
    s_waitcnt lgkmcnt(3)
    v_mfma_f32_16x16x32_f16 v[24:27], v[160:163], v[196:199], v[24:27]
    v_mfma_f32_16x16x32_f16 v[28:31], v[164:167], v[196:199], v[28:31]
    ds_read_b128 v[196:199], v240 offset:31232
    s_waitcnt lgkmcnt(3)
    v_mfma_f32_16x16x32_f16 v[48:51], v[168:171], v[200:203], v[48:51]
    s_mov_b32 s63, 1441792
    buffer_load_dwordx4 v[160:163], v246, s[20:23], s63 offen sc1
    v_mfma_f32_16x16x32_f16 v[52:55], v[172:175], v[200:203], v[52:55]
    ds_read_b128 v[200:203], v241 offset:30208
    s_waitcnt lgkmcnt(3)
    v_mfma_f32_16x16x32_f16 v[56:59], v[168:171], v[204:207], v[56:59]
    s_mov_b32 s41, 1458176
    buffer_load_dwordx4 v[164:167], v246, s[20:23], s41 offen sc1
    v_mfma_f32_16x16x32_f16 v[60:63], v[172:175], v[204:207], v[60:63]
    ds_read_b128 v[204:207], v241 offset:31232
    s_waitcnt lgkmcnt(3)
    v_mfma_f32_16x16x32_f16 v[80:83], v[176:179], v[192:195], v[80:83]
    v_mfma_f32_16x16x32_f16 v[84:87], v[180:183], v[192:195], v[84:87]
    ds_read_b128 v[192:195], v240 offset:34816
    s_waitcnt lgkmcnt(3)
    v_mfma_f32_16x16x32_f16 v[88:91], v[176:179], v[196:199], v[88:91]
    s_mov_b32 s63, 1474560
    buffer_load_dwordx4 v[168:171], v246, s[20:23], s63 offen sc1
    v_mfma_f32_16x16x32_f16 v[92:95], v[180:183], v[196:199], v[92:95]
    ds_read_b128 v[196:199], v240 offset:35840
    s_waitcnt lgkmcnt(3)
    v_mfma_f32_16x16x32_f16 v[112:115], v[184:187], v[200:203], v[112:115]
    v_mfma_f32_16x16x32_f16 v[116:119], v[188:191], v[200:203], v[116:119]
    ds_read_b128 v[200:203], v241 offset:34816
    s_waitcnt lgkmcnt(3)
    v_mfma_f32_16x16x32_f16 v[120:123], v[184:187], v[204:207], v[120:123]
    s_mov_b32 s41, 1490944
    buffer_load_dwordx4 v[172:175], v246, s[20:23], s41 offen sc1
    v_mfma_f32_16x16x32_f16 v[124:127], v[188:191], v[204:207], v[124:127]
    ds_read_b128 v[204:207], v241 offset:35840
    s_bitcmp1_b32 s62, 2
    s_cbranch_scc1 L_RS10
L_RB10:
    s_waitcnt lgkmcnt(3)
    s_waitcnt vmcnt(11)
    v_mfma_f32_16x16x32_f16 v[0:3], v[128:131], v[192:195], v[0:3]
    s_waitcnt vmcnt(10)
    v_mfma_f32_16x16x32_f16 v[4:7], v[132:135], v[192:195], v[4:7]
    ds_read_b128 v[192:195], v240 offset:38912
    s_waitcnt lgkmcnt(3)
    v_mfma_f32_16x16x32_f16 v[8:11], v[128:131], v[196:199], v[8:11]
    v_mfma_f32_16x16x32_f16 v[12:15], v[132:135], v[196:199], v[12:15]
    ds_read_b128 v[196:199], v240 offset:39936
    s_waitcnt lgkmcnt(3)
    s_waitcnt vmcnt(9)
    v_mfma_f32_16x16x32_f16 v[32:35], v[136:139], v[200:203], v[32:35]
    s_mov_b32 s63, 1507328
    buffer_load_dwordx4 v[176:179], v246, s[20:23], s63 offen sc1
    s_waitcnt vmcnt(9)
    v_mfma_f32_16x16x32_f16 v[36:39], v[140:143], v[200:203], v[36:39]
    ds_read_b128 v[200:203], v241 offset:38912
    s_waitcnt lgkmcnt(3)
    v_mfma_f32_16x16x32_f16 v[40:43], v[136:139], v[204:207], v[40:43]
    s_mov_b32 s41, 1523712
    buffer_load_dwordx4 v[180:183], v246, s[20:23], s41 offen sc1
    v_mfma_f32_16x16x32_f16 v[44:47], v[140:143], v[204:207], v[44:47]
    ds_read_b128 v[204:207], v241 offset:39936
    s_waitcnt lgkmcnt(3)
    s_waitcnt vmcnt(9)
    v_mfma_f32_16x16x32_f16 v[64:67], v[144:147], v[192:195], v[64:67]
    s_waitcnt vmcnt(8)
    v_mfma_f32_16x16x32_f16 v[68:71], v[148:151], v[192:195], v[68:71]
    ds_read_b128 v[192:195], v240 offset:43520
    s_waitcnt lgkmcnt(3)
    v_mfma_f32_16x16x32_f16 v[72:75], v[144:147], v[196:199], v[72:75]
    s_mov_b32 s63, 1540096
    buffer_load_dwordx4 v[184:187], v246, s[20:23], s63 offen sc1
    v_mfma_f32_16x16x32_f16 v[76:79], v[148:151], v[196:199], v[76:79]
    ds_read_b128 v[196:199], v240 offset:44544
    s_waitcnt lgkmcnt(3)
    s_waitcnt vmcnt(8)
    v_mfma_f32_16x16x32_f16 v[96:99], v[152:155], v[200:203], v[96:99]
    s_waitcnt vmcnt(7)
    v_mfma_f32_16x16x32_f16 v[100:103], v[156:159], v[200:203], v[100:103]
    ds_read_b128 v[200:203], v241 offset:43520
    s_waitcnt lgkmcnt(3)
    v_mfma_f32_16x16x32_f16 v[104:107], v[152:155], v[204:207], v[104:107]
    s_mov_b32 s41, 1556480
    buffer_load_dwordx4 v[188:191], v246, s[20:23], s41 offen sc1
    v_mfma_f32_16x16x32_f16 v[108:111], v[156:159], v[204:207], v[108:111]
    ds_read_b128 v[204:207], v241 offset:44544
    s_waitcnt lgkmcnt(3)
    v_mfma_f32_16x16x32_f16 v[16:19], v[128:131], v[192:195], v[16:19]
    v_mfma_f32_16x16x32_f16 v[20:23], v[132:135], v[192:195], v[20:23]
    ds_read_b128 v[192:195], v240 offset:47616
    s_waitcnt lgkmcnt(3)
    v_mfma_f32_16x16x32_f16 v[24:27], v[128:131], v[196:199], v[24:27]
    v_mfma_f32_16x16x32_f16 v[28:31], v[132:135], v[196:199], v[28:31]
    ds_read_b128 v[196:199], v240 offset:48640
    s_waitcnt lgkmcnt(3)
    v_mfma_f32_16x16x32_f16 v[48:51], v[136:139], v[200:203], v[48:51]
    s_mov_b32 s63, 1572864
    buffer_load_dwordx4 v[128:131], v246, s[20:23], s63 offen sc1
    v_mfma_f32_16x16x32_f16 v[52:55], v[140:143], v[200:203], v[52:55]
    ds_read_b128 v[200:203], v241 offset:47616
    s_waitcnt lgkmcnt(3)
    v_mfma_f32_16x16x32_f16 v[56:59], v[136:139], v[204:207], v[56:59]
    s_mov_b32 s41, 1589248
    buffer_load_dwordx4 v[132:135], v246, s[20:23], s41 offen sc1
    v_mfma_f32_16x16x32_f16 v[60:63], v[140:143], v[204:207], v[60:63]
    ds_read_b128 v[204:207], v241 offset:48640
    s_waitcnt lgkmcnt(3)
    v_mfma_f32_16x16x32_f16 v[80:83], v[144:147], v[192:195], v[80:83]
    v_mfma_f32_16x16x32_f16 v[84:87], v[148:151], v[192:195], v[84:87]
    ds_read_b128 v[192:195], v240 offset:52224
    s_waitcnt lgkmcnt(3)
    v_mfma_f32_16x16x32_f16 v[88:91], v[144:147], v[196:199], v[88:91]
    s_mov_b32 s63, 1605632
    buffer_load_dwordx4 v[136:139], v246, s[20:23], s63 offen sc1
    v_mfma_f32_16x16x32_f16 v[92:95], v[148:151], v[196:199], v[92:95]
    ds_read_b128 v[196:199], v240 offset:53248
    s_waitcnt lgkmcnt(3)
    v_mfma_f32_16x16x32_f16 v[112:115], v[152:155], v[200:203], v[112:115]
    v_mfma_f32_16x16x32_f16 v[116:119], v[156:159], v[200:203], v[116:119]
    ds_read_b128 v[200:203], v241 offset:52224
    s_waitcnt lgkmcnt(3)
    v_mfma_f32_16x16x32_f16 v[120:123], v[152:155], v[204:207], v[120:123]
    s_mov_b32 s41, 1622016
    buffer_load_dwordx4 v[140:143], v246, s[20:23], s41 offen sc1
    v_mfma_f32_16x16x32_f16 v[124:127], v[156:159], v[204:207], v[124:127]
    ds_read_b128 v[204:207], v241 offset:53248
    s_bitcmp1_b32 s62, 3
    s_cbranch_scc1 L_RS11
L_RB11:
    s_waitcnt lgkmcnt(3)
    s_waitcnt vmcnt(11)
    v_mfma_f32_16x16x32_f16 v[0:3], v[160:163], v[192:195], v[0:3]
    s_waitcnt vmcnt(10)
    v_mfma_f32_16x16x32_f16 v[4:7], v[164:167], v[192:195], v[4:7]
    ds_read_b128 v[192:195], v240 offset:56320
    s_waitcnt lgkmcnt(3)
    v_mfma_f32_16x16x32_f16 v[8:11], v[160:163], v[196:199], v[8:11]
    v_mfma_f32_16x16x32_f16 v[12:15], v[164:167], v[196:199], v[12:15]
    ds_read_b128 v[196:199], v240 offset:57344
    s_waitcnt lgkmcnt(3)
    s_waitcnt vmcnt(9)
    v_mfma_f32_16x16x32_f16 v[32:35], v[168:171], v[200:203], v[32:35]
    s_mov_b32 s63, 1638400
    buffer_load_dwordx4 v[144:147], v246, s[20:23], s63 offen sc1
    s_waitcnt vmcnt(9)
    v_mfma_f32_16x16x32_f16 v[36:39], v[172:175], v[200:203], v[36:39]
    ds_read_b128 v[200:203], v241 offset:56320
    s_waitcnt lgkmcnt(3)
    v_mfma_f32_16x16x32_f16 v[40:43], v[168:171], v[204:207], v[40:43]
    s_mov_b32 s41, 1654784
    buffer_load_dwordx4 v[148:151], v246, s[20:23], s41 offen sc1
    v_mfma_f32_16x16x32_f16 v[44:47], v[172:175], v[204:207], v[44:47]
    ds_read_b128 v[204:207], v241 offset:57344
    s_waitcnt lgkmcnt(3)
    s_waitcnt vmcnt(9)
    v_mfma_f32_16x16x32_f16 v[64:67], v[176:179], v[192:195], v[64:67]
    s_waitcnt vmcnt(8)
    v_mfma_f32_16x16x32_f16 v[68:71], v[180:183], v[192:195], v[68:71]
    ds_read_b128 v[192:195], v240 offset:60928
    s_waitcnt lgkmcnt(3)
    v_mfma_f32_16x16x32_f16 v[72:75], v[176:179], v[196:199], v[72:75]
    s_mov_b32 s63, 1671168
    buffer_load_dwordx4 v[152:155], v246, s[20:23], s63 offen sc1
    v_mfma_f32_16x16x32_f16 v[76:79], v[180:183], v[196:199], v[76:79]
    ds_read_b128 v[196:199], v240 offset:61952
    s_waitcnt lgkmcnt(3)
    s_waitcnt vmcnt(8)
    v_mfma_f32_16x16x32_f16 v[96:99], v[184:187], v[200:203], v[96:99]
    s_waitcnt vmcnt(7)
    v_mfma_f32_16x16x32_f16 v[100:103], v[188:191], v[200:203], v[100:103]
    ds_read_b128 v[200:203], v241 offset:60928
    s_waitcnt lgkmcnt(3)
    v_mfma_f32_16x16x32_f16 v[104:107], v[184:187], v[204:207], v[104:107]
    s_mov_b32 s41, 1687552
    buffer_load_dwordx4 v[156:159], v246, s[20:23], s41 offen sc1
    v_mfma_f32_16x16x32_f16 v[108:111], v[188:191], v[204:207], v[108:111]
    ds_read_b128 v[204:207], v241 offset:61952
    s_waitcnt lgkmcnt(3)
    v_mfma_f32_16x16x32_f16 v[16:19], v[160:163], v[192:195], v[16:19]
    v_mfma_f32_16x16x32_f16 v[20:23], v[164:167], v[192:195], v[20:23]
    ds_read_b128 v[192:195], v240 offset:65024
    s_waitcnt lgkmcnt(3)
    v_mfma_f32_16x16x32_f16 v[24:27], v[160:163], v[196:199], v[24:27]
    v_mfma_f32_16x16x32_f16 v[28:31], v[164:167], v[196:199], v[28:31]
    v_add_u32 v240, 66048, v240
    ds_read_b128 v[196:199], v240 offset:0
    s_waitcnt lgkmcnt(3)
    v_mfma_f32_16x16x32_f16 v[48:51], v[168:171], v[200:203], v[48:51]
    s_mov_b32 s63, 1703936
    buffer_load_dwordx4 v[160:163], v246, s[20:23], s63 offen sc1
    v_mfma_f32_16x16x32_f16 v[52:55], v[172:175], v[200:203], v[52:55]
    ds_read_b128 v[200:203], v241 offset:65024
    s_waitcnt lgkmcnt(3)
    v_mfma_f32_16x16x32_f16 v[56:59], v[168:171], v[204:207], v[56:59]
    s_mov_b32 s41, 1720320
    buffer_load_dwordx4 v[164:167], v246, s[20:23], s41 offen sc1
    v_mfma_f32_16x16x32_f16 v[60:63], v[172:175], v[204:207], v[60:63]
    v_add_u32 v241, 66048, v241
    ds_read_b128 v[204:207], v241 offset:0
    s_waitcnt lgkmcnt(3)
    v_mfma_f32_16x16x32_f16 v[80:83], v[176:179], v[192:195], v[80:83]
    v_mfma_f32_16x16x32_f16 v[84:87], v[180:183], v[192:195], v[84:87]
    ds_read_b128 v[192:195], v240 offset:3584
    s_waitcnt lgkmcnt(3)
    v_mfma_f32_16x16x32_f16 v[88:91], v[176:179], v[196:199], v[88:91]
    s_mov_b32 s63, 1736704
    buffer_load_dwordx4 v[168:171], v246, s[20:23], s63 offen sc1
    v_mfma_f32_16x16x32_f16 v[92:95], v[180:183], v[196:199], v[92:95]
    ds_read_b128 v[196:199], v240 offset:4608
    s_waitcnt lgkmcnt(3)
    v_mfma_f32_16x16x32_f16 v[112:115], v[184:187], v[200:203], v[112:115]
    v_mfma_f32_16x16x32_f16 v[116:119], v[188:191], v[200:203], v[116:119]
    ds_read_b128 v[200:203], v241 offset:3584
    s_waitcnt lgkmcnt(3)
    v_mfma_f32_16x16x32_f16 v[120:123], v[184:187], v[204:207], v[120:123]
    s_mov_b32 s41, 1753088
    buffer_load_dwordx4 v[172:175], v246, s[20:23], s41 offen sc1
    v_mfma_f32_16x16x32_f16 v[124:127], v[188:191], v[204:207], v[124:127]
    ds_read_b128 v[204:207], v241 offset:4608
    s_bitcmp1_b32 s62, 4
    s_cbranch_scc1 L_RS12
L_RB12:
    s_waitcnt lgkmcnt(3)
    s_waitcnt vmcnt(11)
    v_mfma_f32_16x16x32_f16 v[0:3], v[128:131], v[192:195], v[0:3]
    s_waitcnt vmcnt(10)
    v_mfma_f32_16x16x32_f16 v[4:7], v[132:135], v[192:195], v[4:7]
    ds_read_b128 v[192:195], v240 offset:7680
    s_waitcnt lgkmcnt(3)
    v_mfma_f32_16x16x32_f16 v[8:11], v[128:131], v[196:199], v[8:11]
    v_mfma_f32_16x16x32_f16 v[12:15], v[132:135], v[196:199], v[12:15]
    ds_read_b128 v[196:199], v240 offset:8704
    s_waitcnt lgkmcnt(3)
    s_waitcnt vmcnt(9)
    v_mfma_f32_16x16x32_f16 v[32:35], v[136:139], v[200:203], v[32:35]
    s_mov_b32 s63, 1769472
    buffer_load_dwordx4 v[176:179], v246, s[20:23], s63 offen sc1
    s_waitcnt vmcnt(9)
    v_mfma_f32_16x16x32_f16 v[36:39], v[140:143], v[200:203], v[36:39]
    ds_read_b128 v[200:203], v241 offset:7680
    s_waitcnt lgkmcnt(3)
    v_mfma_f32_16x16x32_f16 v[40:43], v[136:139], v[204:207], v[40:43]
    s_mov_b32 s41, 1785856
    buffer_load_dwordx4 v[180:183], v246, s[20:23], s41 offen sc1
    v_mfma_f32_16x16x32_f16 v[44:47], v[140:143], v[204:207], v[44:47]
    ds_read_b128 v[204:207], v241 offset:8704
    s_waitcnt lgkmcnt(3)
    s_waitcnt vmcnt(9)
    v_mfma_f32_16x16x32_f16 v[64:67], v[144:147], v[192:195], v[64:67]
    s_waitcnt vmcnt(8)
    v_mfma_f32_16x16x32_f16 v[68:71], v[148:151], v[192:195], v[68:71]
    ds_read_b128 v[192:195], v240 offset:12288
    s_waitcnt lgkmcnt(3)
    v_mfma_f32_16x16x32_f16 v[72:75], v[144:147], v[196:199], v[72:75]
    s_mov_b32 s63, 1802240
    buffer_load_dwordx4 v[184:187], v246, s[20:23], s63 offen sc1
    v_mfma_f32_16x16x32_f16 v[76:79], v[148:151], v[196:199], v[76:79]
    ds_read_b128 v[196:199], v240 offset:13312
    s_waitcnt lgkmcnt(3)
    s_waitcnt vmcnt(8)
    v_mfma_f32_16x16x32_f16 v[96:99], v[152:155], v[200:203], v[96:99]
    s_waitcnt vmcnt(7)
    v_mfma_f32_16x16x32_f16 v[100:103], v[156:159], v[200:203], v[100:103]
    ds_read_b128 v[200:203], v241 offset:12288
    s_waitcnt lgkmcnt(3)
    v_mfma_f32_16x16x32_f16 v[104:107], v[152:155], v[204:207], v[104:107]
    s_mov_b32 s41, 1818624
    buffer_load_dwordx4 v[188:191], v246, s[20:23], s41 offen sc1
    v_mfma_f32_16x16x32_f16 v[108:111], v[156:159], v[204:207], v[108:111]
    ds_read_b128 v[204:207], v241 offset:13312
    s_waitcnt lgkmcnt(3)
    v_mfma_f32_16x16x32_f16 v[16:19], v[128:131], v[192:195], v[16:19]
    v_mfma_f32_16x16x32_f16 v[20:23], v[132:135], v[192:195], v[20:23]
    ds_read_b128 v[192:195], v240 offset:16384
    s_waitcnt lgkmcnt(3)
    v_mfma_f32_16x16x32_f16 v[24:27], v[128:131], v[196:199], v[24:27]
    v_mfma_f32_16x16x32_f16 v[28:31], v[132:135], v[196:199], v[28:31]
    ds_read_b128 v[196:199], v240 offset:17408
    s_waitcnt lgkmcnt(3)
    v_mfma_f32_16x16x32_f16 v[48:51], v[136:139], v[200:203], v[48:51]
    s_mov_b32 s63, 1835008
    buffer_load_dwordx4 v[128:131], v246, s[20:23], s63 offen sc1
    v_mfma_f32_16x16x32_f16 v[52:55], v[140:143], v[200:203], v[52:55]
    ds_read_b128 v[200:203], v241 offset:16384
    s_waitcnt lgkmcnt(3)
    v_mfma_f32_16x16x32_f16 v[56:59], v[136:139], v[204:207], v[56:59]
    s_mov_b32 s41, 1851392
    buffer_load_dwordx4 v[132:135], v246, s[20:23], s41 offen sc1
    v_mfma_f32_16x16x32_f16 v[60:63], v[140:143], v[204:207], v[60:63]
    ds_read_b128 v[204:207], v241 offset:17408
    s_waitcnt lgkmcnt(3)
    v_mfma_f32_16x16x32_f16 v[80:83], v[144:147], v[192:195], v[80:83]
    v_mfma_f32_16x16x32_f16 v[84:87], v[148:151], v[192:195], v[84:87]
    ds_read_b128 v[192:195], v240 offset:20992
    s_waitcnt lgkmcnt(3)
    v_mfma_f32_16x16x32_f16 v[88:91], v[144:147], v[196:199], v[88:91]
    s_mov_b32 s63, 1867776
    buffer_load_dwordx4 v[136:139], v246, s[20:23], s63 offen sc1
    v_mfma_f32_16x16x32_f16 v[92:95], v[148:151], v[196:199], v[92:95]
    ds_read_b128 v[196:199], v240 offset:22016
    s_waitcnt lgkmcnt(3)
    v_mfma_f32_16x16x32_f16 v[112:115], v[152:155], v[200:203], v[112:115]
    v_mfma_f32_16x16x32_f16 v[116:119], v[156:159], v[200:203], v[116:119]
    ds_read_b128 v[200:203], v241 offset:20992
    s_waitcnt lgkmcnt(3)
    v_mfma_f32_16x16x32_f16 v[120:123], v[152:155], v[204:207], v[120:123]
    s_mov_b32 s41, 1884160
    buffer_load_dwordx4 v[140:143], v246, s[20:23], s41 offen sc1
    v_mfma_f32_16x16x32_f16 v[124:127], v[156:159], v[204:207], v[124:127]
    ds_read_b128 v[204:207], v241 offset:22016
    s_bitcmp1_b32 s62, 5
    s_cbranch_scc1 L_RS13
L_RB13:
    s_waitcnt lgkmcnt(3)
    s_waitcnt vmcnt(11)
    v_mfma_f32_16x16x32_f16 v[0:3], v[160:163], v[192:195], v[0:3]
    s_waitcnt vmcnt(10)
    v_mfma_f32_16x16x32_f16 v[4:7], v[164:167], v[192:195], v[4:7]
    ds_read_b128 v[192:195], v240 offset:25088
    s_waitcnt lgkmcnt(3)
    v_mfma_f32_16x16x32_f16 v[8:11], v[160:163], v[196:199], v[8:11]
    v_mfma_f32_16x16x32_f16 v[12:15], v[164:167], v[196:199], v[12:15]
    ds_read_b128 v[196:199], v240 offset:26112
    s_waitcnt lgkmcnt(3)
    s_waitcnt vmcnt(9)
    v_mfma_f32_16x16x32_f16 v[32:35], v[168:171], v[200:203], v[32:35]
    s_mov_b32 s63, 1900544
    buffer_load_dwordx4 v[144:147], v246, s[20:23], s63 offen sc1
    s_waitcnt vmcnt(9)
    v_mfma_f32_16x16x32_f16 v[36:39], v[172:175], v[200:203], v[36:39]
    ds_read_b128 v[200:203], v241 offset:25088
    s_waitcnt lgkmcnt(3)
    v_mfma_f32_16x16x32_f16 v[40:43], v[168:171], v[204:207], v[40:43]
    s_mov_b32 s41, 1916928
    buffer_load_dwordx4 v[148:151], v246, s[20:23], s41 offen sc1
    v_mfma_f32_16x16x32_f16 v[44:47], v[172:175], v[204:207], v[44:47]
    ds_read_b128 v[204:207], v241 offset:26112
    s_waitcnt lgkmcnt(3)
    s_waitcnt vmcnt(9)
    v_mfma_f32_16x16x32_f16 v[64:67], v[176:179], v[192:195], v[64:67]
    s_waitcnt vmcnt(8)
    v_mfma_f32_16x16x32_f16 v[68:71], v[180:183], v[192:195], v[68:71]
    ds_read_b128 v[192:195], v240 offset:29696
    s_waitcnt lgkmcnt(3)
    v_mfma_f32_16x16x32_f16 v[72:75], v[176:179], v[196:199], v[72:75]
    s_mov_b32 s63, 1933312
    buffer_load_dwordx4 v[152:155], v246, s[20:23], s63 offen sc1
    v_mfma_f32_16x16x32_f16 v[76:79], v[180:183], v[196:199], v[76:79]
    ds_read_b128 v[196:199], v240 offset:30720
    s_waitcnt lgkmcnt(3)
    s_waitcnt vmcnt(8)
    v_mfma_f32_16x16x32_f16 v[96:99], v[184:187], v[200:203], v[96:99]
    s_waitcnt vmcnt(7)
    v_mfma_f32_16x16x32_f16 v[100:103], v[188:191], v[200:203], v[100:103]
    ds_read_b128 v[200:203], v241 offset:29696
    s_waitcnt lgkmcnt(3)
    v_mfma_f32_16x16x32_f16 v[104:107], v[184:187], v[204:207], v[104:107]
    s_mov_b32 s41, 1949696
    buffer_load_dwordx4 v[156:159], v246, s[20:23], s41 offen sc1
    v_mfma_f32_16x16x32_f16 v[108:111], v[188:191], v[204:207], v[108:111]
    ds_read_b128 v[204:207], v241 offset:30720
    s_waitcnt lgkmcnt(3)
    v_mfma_f32_16x16x32_f16 v[16:19], v[160:163], v[192:195], v[16:19]
    v_mfma_f32_16x16x32_f16 v[20:23], v[164:167], v[192:195], v[20:23]
    ds_read_b128 v[192:195], v240 offset:33792
    s_waitcnt lgkmcnt(3)
    v_mfma_f32_16x16x32_f16 v[24:27], v[160:163], v[196:199], v[24:27]
    v_mfma_f32_16x16x32_f16 v[28:31], v[164:167], v[196:199], v[28:31]
    ds_read_b128 v[196:199], v240 offset:34816
    s_waitcnt lgkmcnt(3)
    v_mfma_f32_16x16x32_f16 v[48:51], v[168:171], v[200:203], v[48:51]
    s_mov_b32 s63, 1966080
    buffer_load_dwordx4 v[160:163], v246, s[20:23], s63 offen sc1
    v_mfma_f32_16x16x32_f16 v[52:55], v[172:175], v[200:203], v[52:55]
    ds_read_b128 v[200:203], v241 offset:33792
    s_waitcnt lgkmcnt(3)
    v_mfma_f32_16x16x32_f16 v[56:59], v[168:171], v[204:207], v[56:59]
    s_mov_b32 s41, 1982464
    buffer_load_dwordx4 v[164:167], v246, s[20:23], s41 offen sc1
    v_mfma_f32_16x16x32_f16 v[60:63], v[172:175], v[204:207], v[60:63]
    ds_read_b128 v[204:207], v241 offset:34816
    s_waitcnt lgkmcnt(3)
    v_mfma_f32_16x16x32_f16 v[80:83], v[176:179], v[192:195], v[80:83]
    v_mfma_f32_16x16x32_f16 v[84:87], v[180:183], v[192:195], v[84:87]
    ds_read_b128 v[192:195], v240 offset:38400
    s_waitcnt lgkmcnt(3)
    v_mfma_f32_16x16x32_f16 v[88:91], v[176:179], v[196:199], v[88:91]
    s_mov_b32 s63, 1998848
    buffer_load_dwordx4 v[168:171], v246, s[20:23], s63 offen sc1
    v_mfma_f32_16x16x32_f16 v[92:95], v[180:183], v[196:199], v[92:95]
    ds_read_b128 v[196:199], v240 offset:39424
    s_waitcnt lgkmcnt(3)
    v_mfma_f32_16x16x32_f16 v[112:115], v[184:187], v[200:203], v[112:115]
    v_mfma_f32_16x16x32_f16 v[116:119], v[188:191], v[200:203], v[116:119]
    ds_read_b128 v[200:203], v241 offset:38400
    s_waitcnt lgkmcnt(3)
    v_mfma_f32_16x16x32_f16 v[120:123], v[184:187], v[204:207], v[120:123]
    s_mov_b32 s41, 2015232
    buffer_load_dwordx4 v[172:175], v246, s[20:23], s41 offen sc1
    v_mfma_f32_16x16x32_f16 v[124:127], v[188:191], v[204:207], v[124:127]
    ds_read_b128 v[204:207], v241 offset:39424
    s_bitcmp1_b32 s62, 6
    s_cbranch_scc1 L_RS14
L_RB14:
    s_waitcnt lgkmcnt(3)
    s_waitcnt vmcnt(11)
    v_mfma_f32_16x16x32_f16 v[0:3], v[128:131], v[192:195], v[0:3]
    s_waitcnt vmcnt(10)
    v_mfma_f32_16x16x32_f16 v[4:7], v[132:135], v[192:195], v[4:7]
    ds_read_b128 v[192:195], v240 offset:42496
    s_waitcnt lgkmcnt(3)
    v_mfma_f32_16x16x32_f16 v[8:11], v[128:131], v[196:199], v[8:11]
    v_mfma_f32_16x16x32_f16 v[12:15], v[132:135], v[196:199], v[12:15]
    ds_read_b128 v[196:199], v240 offset:43520
    s_waitcnt lgkmcnt(3)
    s_waitcnt vmcnt(9)
    v_mfma_f32_16x16x32_f16 v[32:35], v[136:139], v[200:203], v[32:35]
    s_mov_b32 s63, 2031616
    buffer_load_dwordx4 v[176:179], v246, s[20:23], s63 offen sc1
    s_waitcnt vmcnt(9)
    v_mfma_f32_16x16x32_f16 v[36:39], v[140:143], v[200:203], v[36:39]
    ds_read_b128 v[200:203], v241 offset:42496
    s_waitcnt lgkmcnt(3)
    v_mfma_f32_16x16x32_f16 v[40:43], v[136:139], v[204:207], v[40:43]
    s_mov_b32 s41, 2048000
    buffer_load_dwordx4 v[180:183], v246, s[20:23], s41 offen sc1
    v_mfma_f32_16x16x32_f16 v[44:47], v[140:143], v[204:207], v[44:47]
    ds_read_b128 v[204:207], v241 offset:43520
    s_waitcnt lgkmcnt(3)
    s_waitcnt vmcnt(9)
    v_mfma_f32_16x16x32_f16 v[64:67], v[144:147], v[192:195], v[64:67]
    s_waitcnt vmcnt(8)
    v_mfma_f32_16x16x32_f16 v[68:71], v[148:151], v[192:195], v[68:71]
    ds_read_b128 v[192:195], v240 offset:47104
    s_waitcnt lgkmcnt(3)
    v_mfma_f32_16x16x32_f16 v[72:75], v[144:147], v[196:199], v[72:75]
    s_mov_b32 s63, 2064384
    buffer_load_dwordx4 v[184:187], v246, s[20:23], s63 offen sc1
    v_mfma_f32_16x16x32_f16 v[76:79], v[148:151], v[196:199], v[76:79]
    ds_read_b128 v[196:199], v240 offset:48128
    s_waitcnt lgkmcnt(3)
    s_waitcnt vmcnt(8)
    v_mfma_f32_16x16x32_f16 v[96:99], v[152:155], v[200:203], v[96:99]
    s_waitcnt vmcnt(7)
    v_mfma_f32_16x16x32_f16 v[100:103], v[156:159], v[200:203], v[100:103]
    ds_read_b128 v[200:203], v241 offset:47104
    s_waitcnt lgkmcnt(3)
    v_mfma_f32_16x16x32_f16 v[104:107], v[152:155], v[204:207], v[104:107]
    s_mov_b32 s41, 2080768
    buffer_load_dwordx4 v[188:191], v246, s[20:23], s41 offen sc1
    v_mfma_f32_16x16x32_f16 v[108:111], v[156:159], v[204:207], v[108:111]
    ds_read_b128 v[204:207], v241 offset:48128
    s_waitcnt lgkmcnt(3)
    v_mfma_f32_16x16x32_f16 v[16:19], v[128:131], v[192:195], v[16:19]
    v_mfma_f32_16x16x32_f16 v[20:23], v[132:135], v[192:195], v[20:23]
    ds_read_b128 v[192:195], v240 offset:51200
    s_waitcnt lgkmcnt(3)
    v_mfma_f32_16x16x32_f16 v[24:27], v[128:131], v[196:199], v[24:27]
    v_mfma_f32_16x16x32_f16 v[28:31], v[132:135], v[196:199], v[28:31]
    ds_read_b128 v[196:199], v240 offset:52224
    s_waitcnt lgkmcnt(3)
    v_mfma_f32_16x16x32_f16 v[48:51], v[136:139], v[200:203], v[48:51]
    buffer_load_dwordx4 v[128:131], v247, s[20:23], s32 offen offset:0 sc1
    v_mfma_f32_16x16x32_f16 v[52:55], v[140:143], v[200:203], v[52:55]
    ds_read_b128 v[200:203], v241 offset:51200
    s_waitcnt lgkmcnt(3)
    v_mfma_f32_16x16x32_f16 v[56:59], v[136:139], v[204:207], v[56:59]
    buffer_load_dwordx4 v[132:135], v247, s[20:23], s32 offen offset:1024 sc1
    v_mfma_f32_16x16x32_f16 v[60:63], v[140:143], v[204:207], v[60:63]
    ds_read_b128 v[204:207], v241 offset:52224
    s_waitcnt lgkmcnt(3)
    v_mfma_f32_16x16x32_f16 v[80:83], v[144:147], v[192:195], v[80:83]
    v_mfma_f32_16x16x32_f16 v[84:87], v[148:151], v[192:195], v[84:87]
    ds_read_b128 v[192:195], v240 offset:55808
    s_waitcnt lgkmcnt(3)
    v_mfma_f32_16x16x32_f16 v[88:91], v[144:147], v[196:199], v[88:91]
    buffer_load_dwordx4 v[136:139], v247, s[20:23], s32 offen offset:2048 sc1
    v_mfma_f32_16x16x32_f16 v[92:95], v[148:151], v[196:199], v[92:95]
    ds_read_b128 v[196:199], v240 offset:56832
    s_waitcnt lgkmcnt(3)
    v_mfma_f32_16x16x32_f16 v[112:115], v[152:155], v[200:203], v[112:115]
    v_mfma_f32_16x16x32_f16 v[116:119], v[156:159], v[200:203], v[116:119]
    ds_read_b128 v[200:203], v241 offset:55808
    s_waitcnt lgkmcnt(3)
    v_mfma_f32_16x16x32_f16 v[120:123], v[152:155], v[204:207], v[120:123]
    buffer_load_dwordx4 v[140:143], v247, s[20:23], s32 offen offset:3072 sc1
    v_mfma_f32_16x16x32_f16 v[124:127], v[156:159], v[204:207], v[124:127]
    ds_read_b128 v[204:207], v241 offset:56832
    s_bitcmp1_b32 s62, 7
    s_cbranch_scc1 L_RS15
L_RB15:
    s_waitcnt lgkmcnt(3)
    s_waitcnt vmcnt(11)
    v_mfma_f32_16x16x32_f16 v[0:3], v[160:163], v[192:195], v[0:3]
    s_waitcnt vmcnt(10)
    v_mfma_f32_16x16x32_f16 v[4:7], v[164:167], v[192:195], v[4:7]
    ds_read_b128 v[192:195], v240 offset:59904
    s_waitcnt lgkmcnt(3)
    v_mfma_f32_16x16x32_f16 v[8:11], v[160:163], v[196:199], v[8:11]
    v_mfma_f32_16x16x32_f16 v[12:15], v[164:167], v[196:199], v[12:15]
    ds_read_b128 v[196:199], v240 offset:60928
    s_waitcnt lgkmcnt(3)
    s_waitcnt vmcnt(9)
    v_mfma_f32_16x16x32_f16 v[32:35], v[168:171], v[200:203], v[32:35]
    buffer_load_dwordx4 v[144:147], v247, s[20:23], s33 offen offset:0 sc1
    s_waitcnt vmcnt(9)
    v_mfma_f32_16x16x32_f16 v[36:39], v[172:175], v[200:203], v[36:39]
    ds_read_b128 v[200:203], v241 offset:59904
    s_waitcnt lgkmcnt(3)
    v_mfma_f32_16x16x32_f16 v[40:43], v[168:171], v[204:207], v[40:43]
    buffer_load_dwordx4 v[148:151], v247, s[20:23], s33 offen offset:1024 sc1
    v_mfma_f32_16x16x32_f16 v[44:47], v[172:175], v[204:207], v[44:47]
    ds_read_b128 v[204:207], v241 offset:60928
    s_waitcnt lgkmcnt(3)
    s_waitcnt vmcnt(9)
    v_mfma_f32_16x16x32_f16 v[64:67], v[176:179], v[192:195], v[64:67]
    s_waitcnt vmcnt(8)
    v_mfma_f32_16x16x32_f16 v[68:71], v[180:183], v[192:195], v[68:71]
    ds_read_b128 v[192:195], v240 offset:64512
    s_waitcnt lgkmcnt(3)
    v_mfma_f32_16x16x32_f16 v[72:75], v[176:179], v[196:199], v[72:75]
    buffer_load_dwordx4 v[152:155], v247, s[20:23], s33 offen offset:2048 sc1
    v_mfma_f32_16x16x32_f16 v[76:79], v[180:183], v[196:199], v[76:79]
    v_add_u32 v240, 65536, v240
    ds_read_b128 v[196:199], v240 offset:0
    s_waitcnt lgkmcnt(3)
    s_waitcnt vmcnt(8)
    v_mfma_f32_16x16x32_f16 v[96:99], v[184:187], v[200:203], v[96:99]
    s_waitcnt vmcnt(7)
    v_mfma_f32_16x16x32_f16 v[100:103], v[188:191], v[200:203], v[100:103]
    ds_read_b128 v[200:203], v241 offset:64512
    s_waitcnt lgkmcnt(3)
    v_mfma_f32_16x16x32_f16 v[104:107], v[184:187], v[204:207], v[104:107]
    buffer_load_dwordx4 v[156:159], v247, s[20:23], s33 offen offset:3072 sc1
    v_mfma_f32_16x16x32_f16 v[108:111], v[188:191], v[204:207], v[108:111]
    v_add_u32 v241, 65536, v241
    ds_read_b128 v[204:207], v241 offset:0
    s_waitcnt lgkmcnt(3)
    v_mfma_f32_16x16x32_f16 v[16:19], v[160:163], v[192:195], v[16:19]
    v_mfma_f32_16x16x32_f16 v[20:23], v[164:167], v[192:195], v[20:23]
    ds_read_b128 v[192:195], v240 offset:3072
    s_waitcnt lgkmcnt(3)
    v_mfma_f32_16x16x32_f16 v[24:27], v[160:163], v[196:199], v[24:27]
    v_mfma_f32_16x16x32_f16 v[28:31], v[164:167], v[196:199], v[28:31]
    ds_read_b128 v[196:199], v240 offset:4096
    s_waitcnt lgkmcnt(3)
    v_mfma_f32_16x16x32_f16 v[48:51], v[168:171], v[200:203], v[48:51]
    buffer_load_dwordx4 v[160:163], v247, s[20:23], s34 offen offset:0 sc1
    v_mfma_f32_16x16x32_f16 v[52:55], v[172:175], v[200:203], v[52:55]
    ds_read_b128 v[200:203], v241 offset:3072
    s_waitcnt lgkmcnt(3)
    v_mfma_f32_16x16x32_f16 v[56:59], v[168:171], v[204:207], v[56:59]
    buffer_load_dwordx4 v[164:167], v247, s[20:23], s34 offen offset:1024 sc1
    v_mfma_f32_16x16x32_f16 v[60:63], v[172:175], v[204:207], v[60:63]
    ds_read_b128 v[204:207], v241 offset:4096
    s_waitcnt lgkmcnt(3)
    v_mfma_f32_16x16x32_f16 v[80:83], v[176:179], v[192:195], v[80:83]
    v_mfma_f32_16x16x32_f16 v[84:87], v[180:183], v[192:195], v[84:87]
    s_waitcnt lgkmcnt(2)
    v_mfma_f32_16x16x32_f16 v[88:91], v[176:179], v[196:199], v[88:91]
    buffer_load_dwordx4 v[168:171], v247, s[20:23], s34 offen offset:2048 sc1
    v_mfma_f32_16x16x32_f16 v[92:95], v[180:183], v[196:199], v[92:95]
    s_waitcnt lgkmcnt(1)
    v_mfma_f32_16x16x32_f16 v[112:115], v[184:187], v[200:203], v[112:115]
    v_mfma_f32_16x16x32_f16 v[116:119], v[188:191], v[200:203], v[116:119]
    s_waitcnt lgkmcnt(0)
    v_mfma_f32_16x16x32_f16 v[120:123], v[184:187], v[204:207], v[120:123]
    buffer_load_dwordx4 v[172:175], v247, s[20:23], s34 offen offset:3072 sc1
    v_mfma_f32_16x16x32_f16 v[124:127], v[188:191], v[204:207], v[124:127]
    buffer_load_dwordx4 v[176:179], v247, s[20:23], s35 offen offset:0 sc1
    buffer_load_dwordx4 v[180:183], v247, s[20:23], s35 offen offset:1024 sc1
    buffer_load_dwordx4 v[184:187], v247, s[20:23], s35 offen offset:2048 sc1
    buffer_load_dwordx4 v[188:191], v247, s[20:23], s35 offen offset:3072 sc1
    v_mul_f32 v224, s56, v0
    v_fma_f32 v0, s56, v32, v224
    v_fma_f32 v32, -s56, v32, v224
    v_fma_f32 v64, s58, v64, v0
    v_fma_f32 v96, s60, v96, v32
    v_mul_f32 v225, s56, v1
    v_fma_f32 v1, s56, v33, v225
    v_fma_f32 v33, -s56, v33, v225
    v_fma_f32 v65, s58, v65, v1
    v_fma_f32 v97, s60, v97, v33
    v_mul_f32 v226, s56, v2
    v_fma_f32 v2, s56, v34, v226
    v_fma_f32 v34, -s56, v34, v226
    v_fma_f32 v66, s58, v66, v2
    v_fma_f32 v98, s60, v98, v34
    v_mul_f32 v227, s56, v3
    v_fma_f32 v3, s56, v35, v227
    v_fma_f32 v35, -s56, v35, v227
    v_fma_f32 v67, s58, v67, v3
    v_fma_f32 v99, s60, v99, v35
    v_mul_f32 v228, s57, v4
    v_fma_f32 v4, s57, v36, v228
    v_fma_f32 v36, -s57, v36, v228
    v_fma_f32 v68, s59, v68, v4
    v_fma_f32 v100, s61, v100, v36
    v_mul_f32 v229, s57, v5
    v_fma_f32 v5, s57, v37, v229
    v_fma_f32 v37, -s57, v37, v229
    v_fma_f32 v69, s59, v69, v5
    v_fma_f32 v101, s61, v101, v37
    v_mul_f32 v230, s57, v6
    v_fma_f32 v6, s57, v38, v230
    v_fma_f32 v38, -s57, v38, v230
    v_fma_f32 v70, s59, v70, v6
    v_fma_f32 v102, s61, v102, v38
    v_mul_f32 v231, s57, v7
    v_fma_f32 v7, s57, v39, v231
    v_fma_f32 v39, -s57, v39, v231
    v_fma_f32 v71, s59, v71, v7
    v_fma_f32 v103, s61, v103, v39
    v_min_f32 v64, s40, v64
    v_min_f32 v65, s40, v65
    v_min_f32 v66, s40, v66
    v_min_f32 v67, s40, v67
    v_exp_f32 v64, v64
    v_exp_f32 v68, v68
    v_exp_f32 v65, v65
    v_exp_f32 v69, v69
    v_exp_f32 v66, v66
    v_exp_f32 v70, v70
    v_exp_f32 v67, v67
    v_exp_f32 v71, v71
    v_add_f32 v224, 1.0, v64
    v_sub_f32 v64, 1.0, v64
    v_fma_f32 v68, v224, v68, v224
    v_add_f32 v225, 1.0, v65
    v_sub_f32 v65, 1.0, v65
    v_fma_f32 v69, v225, v69, v225
    v_add_f32 v226, 1.0, v66
    v_sub_f32 v66, 1.0, v66
    v_fma_f32 v70, v226, v70, v226
    v_add_f32 v227, 1.0, v67
    v_sub_f32 v67, 1.0, v67
    v_fma_f32 v71, v227, v71, v227
    v_rcp_f32 v68, v68
    v_rcp_f32 v69, v69
    v_rcp_f32 v70, v70
    v_rcp_f32 v71, v71
    v_mul_f32 v64, v64, v68
    v_mul_f32 v65, v65, v69
    v_mul_f32 v66, v66, v70
    v_mul_f32 v67, v67, v71
    v_cvt_pk_bf16_f32 v68, v64, v65
    v_cvt_pk_bf16_f32 v69, v66, v67
    v_min_f32 v32, s40, v32
    v_min_f32 v33, s40, v33
    v_min_f32 v34, s40, v34
    v_min_f32 v35, s40, v35
    v_exp_f32 v32, v32
    v_exp_f32 v36, v36
    v_exp_f32 v33, v33
    v_exp_f32 v37, v37
    v_exp_f32 v34, v34
    v_exp_f32 v38, v38
    v_exp_f32 v35, v35
    v_exp_f32 v39, v39
    v_add_f32 v224, 1.0, v32
    v_sub_f32 v32, 1.0, v32
    v_fma_f32 v36, v224, v36, v224
    v_add_f32 v225, 1.0, v33
    v_sub_f32 v33, 1.0, v33
    v_fma_f32 v37, v225, v37, v225
    v_add_f32 v226, 1.0, v34
    v_sub_f32 v34, 1.0, v34
    v_fma_f32 v38, v226, v38, v226
    v_add_f32 v227, 1.0, v35
    v_sub_f32 v35, 1.0, v35
    v_fma_f32 v39, v227, v39, v227
    v_rcp_f32 v36, v36
    v_rcp_f32 v37, v37
    v_rcp_f32 v38, v38
    v_rcp_f32 v39, v39
    v_mul_f32 v32, v32, v36
    v_mul_f32 v33, v33, v37
    v_mul_f32 v34, v34, v38
    v_mul_f32 v35, v35, v39
    v_cvt_pk_bf16_f32 v70, v32, v33
    v_cvt_pk_bf16_f32 v71, v34, v35
    v_min_f32 v0, s40, v0
    v_min_f32 v1, s40, v1
    v_min_f32 v2, s40, v2
    v_min_f32 v3, s40, v3
    v_exp_f32 v0, v0
    v_exp_f32 v4, v4
    v_exp_f32 v1, v1
    v_exp_f32 v5, v5
    v_exp_f32 v2, v2
    v_exp_f32 v6, v6
    v_exp_f32 v3, v3
    v_exp_f32 v7, v7
    v_add_f32 v224, 1.0, v0
    v_sub_f32 v0, 1.0, v0
    v_fma_f32 v4, v224, v4, v224
    v_add_f32 v225, 1.0, v1
    v_sub_f32 v1, 1.0, v1
    v_fma_f32 v5, v225, v5, v225
    v_add_f32 v226, 1.0, v2
    v_sub_f32 v2, 1.0, v2
    v_fma_f32 v6, v226, v6, v226
    v_add_f32 v227, 1.0, v3
    v_sub_f32 v3, 1.0, v3
    v_fma_f32 v7, v227, v7, v227
    v_rcp_f32 v4, v4
    v_rcp_f32 v5, v5
    v_rcp_f32 v6, v6
    v_rcp_f32 v7, v7
    v_mul_f32 v0, v0, v4
    v_mul_f32 v1, v1, v5
    v_mul_f32 v2, v2, v6
    v_mul_f32 v3, v3, v7
    v_cvt_pk_bf16_f32 v4, v0, v1
    v_cvt_pk_bf16_f32 v5, v2, v3
    v_min_f32 v96, s40, v96
    v_min_f32 v97, s40, v97
    v_min_f32 v98, s40, v98
    v_min_f32 v99, s40, v99
    v_exp_f32 v96, v96
    v_exp_f32 v100, v100
    v_exp_f32 v97, v97
    v_exp_f32 v101, v101
    v_exp_f32 v98, v98
    v_exp_f32 v102, v102
    v_exp_f32 v99, v99
    v_exp_f32 v103, v103
    v_add_f32 v224, 1.0, v96
    v_sub_f32 v96, 1.0, v96
    v_fma_f32 v100, v224, v100, v224
    v_add_f32 v225, 1.0, v97
    v_sub_f32 v97, 1.0, v97
    v_fma_f32 v101, v225, v101, v225
    v_add_f32 v226, 1.0, v98
    v_sub_f32 v98, 1.0, v98
    v_fma_f32 v102, v226, v102, v226
    v_add_f32 v227, 1.0, v99
    v_sub_f32 v99, 1.0, v99
    v_fma_f32 v103, v227, v103, v227
    v_rcp_f32 v100, v100
    v_rcp_f32 v101, v101
    v_rcp_f32 v102, v102
    v_rcp_f32 v103, v103
    v_mul_f32 v96, v96, v100
    v_mul_f32 v97, v97, v101
    v_mul_f32 v98, v98, v102
    v_mul_f32 v99, v99, v103
    v_cvt_pk_bf16_f32 v6, v96, v97
    v_cvt_pk_bf16_f32 v7, v98, v99
    buffer_store_dwordx4 v[68:71], v247, s[20:23], s37 offen offset:0 sc1
    buffer_store_dwordx4 v[4:7], v247, s[20:23], s37 offen offset:1024 sc1
    v_mul_f32 v224, s56, v8
    v_fma_f32 v8, s56, v40, v224
    v_fma_f32 v40, -s56, v40, v224
    v_fma_f32 v72, s58, v72, v8
    v_fma_f32 v104, s60, v104, v40
    v_mul_f32 v225, s56, v9
    v_fma_f32 v9, s56, v41, v225
    v_fma_f32 v41, -s56, v41, v225
    v_fma_f32 v73, s58, v73, v9
    v_fma_f32 v105, s60, v105, v41
    v_mul_f32 v226, s56, v10
    v_fma_f32 v10, s56, v42, v226
    v_fma_f32 v42, -s56, v42, v226
    v_fma_f32 v74, s58, v74, v10
    v_fma_f32 v106, s60, v106, v42
    v_mul_f32 v227, s56, v11
    v_fma_f32 v11, s56, v43, v227
    v_fma_f32 v43, -s56, v43, v227
    v_fma_f32 v75, s58, v75, v11
    v_fma_f32 v107, s60, v107, v43
    v_mul_f32 v228, s57, v12
    v_fma_f32 v12, s57, v44, v228
    v_fma_f32 v44, -s57, v44, v228
    v_fma_f32 v76, s59, v76, v12
    v_fma_f32 v108, s61, v108, v44
    v_mul_f32 v229, s57, v13
    v_fma_f32 v13, s57, v45, v229
    v_fma_f32 v45, -s57, v45, v229
    v_fma_f32 v77, s59, v77, v13
    v_fma_f32 v109, s61, v109, v45
    v_mul_f32 v230, s57, v14
    v_fma_f32 v14, s57, v46, v230
    v_fma_f32 v46, -s57, v46, v230
    v_fma_f32 v78, s59, v78, v14
    v_fma_f32 v110, s61, v110, v46
    v_mul_f32 v231, s57, v15
    v_fma_f32 v15, s57, v47, v231
    v_fma_f32 v47, -s57, v47, v231
    v_fma_f32 v79, s59, v79, v15
    v_fma_f32 v111, s61, v111, v47
    v_min_f32 v72, s40, v72
    v_min_f32 v73, s40, v73
    v_min_f32 v74, s40, v74
    v_min_f32 v75, s40, v75
    v_exp_f32 v72, v72
    v_exp_f32 v76, v76
    v_exp_f32 v73, v73
    v_exp_f32 v77, v77
    v_exp_f32 v74, v74
    v_exp_f32 v78, v78
    v_exp_f32 v75, v75
    v_exp_f32 v79, v79
    v_add_f32 v224, 1.0, v72
    v_sub_f32 v72, 1.0, v72
    v_fma_f32 v76, v224, v76, v224
    v_add_f32 v225, 1.0, v73
    v_sub_f32 v73, 1.0, v73
    v_fma_f32 v77, v225, v77, v225
    v_add_f32 v226, 1.0, v74
    v_sub_f32 v74, 1.0, v74
    v_fma_f32 v78, v226, v78, v226
    v_add_f32 v227, 1.0, v75
    v_sub_f32 v75, 1.0, v75
    v_fma_f32 v79, v227, v79, v227
    v_rcp_f32 v76, v76
    v_rcp_f32 v77, v77
    v_rcp_f32 v78, v78
    v_rcp_f32 v79, v79
    v_mul_f32 v72, v72, v76
    v_mul_f32 v73, v73, v77
    v_mul_f32 v74, v74, v78
    v_mul_f32 v75, v75, v79
    v_cvt_pk_bf16_f32 v76, v72, v73
    v_cvt_pk_bf16_f32 v77, v74, v75
    v_min_f32 v40, s40, v40
    v_min_f32 v41, s40, v41
    v_min_f32 v42, s40, v42
    v_min_f32 v43, s40, v43
    v_exp_f32 v40, v40
    v_exp_f32 v44, v44
    v_exp_f32 v41, v41
    v_exp_f32 v45, v45
    v_exp_f32 v42, v42
    v_exp_f32 v46, v46
    v_exp_f32 v43, v43
    v_exp_f32 v47, v47
    v_add_f32 v224, 1.0, v40
    v_sub_f32 v40, 1.0, v40
    v_fma_f32 v44, v224, v44, v224
    v_add_f32 v225, 1.0, v41
    v_sub_f32 v41, 1.0, v41
    v_fma_f32 v45, v225, v45, v225
    v_add_f32 v226, 1.0, v42
    v_sub_f32 v42, 1.0, v42
    v_fma_f32 v46, v226, v46, v226
    v_add_f32 v227, 1.0, v43
    v_sub_f32 v43, 1.0, v43
    v_fma_f32 v47, v227, v47, v227
    v_rcp_f32 v44, v44
    v_rcp_f32 v45, v45
    v_rcp_f32 v46, v46
    v_rcp_f32 v47, v47
    v_mul_f32 v40, v40, v44
    v_mul_f32 v41, v41, v45
    v_mul_f32 v42, v42, v46
    v_mul_f32 v43, v43, v47
    v_cvt_pk_bf16_f32 v78, v40, v41
    v_cvt_pk_bf16_f32 v79, v42, v43
    v_min_f32 v8, s40, v8
    v_min_f32 v9, s40, v9
    v_min_f32 v10, s40, v10
    v_min_f32 v11, s40, v11
    v_exp_f32 v8, v8
    v_exp_f32 v12, v12
    v_exp_f32 v9, v9
    v_exp_f32 v13, v13
    v_exp_f32 v10, v10
    v_exp_f32 v14, v14
    v_exp_f32 v11, v11
    v_exp_f32 v15, v15
    v_add_f32 v224, 1.0, v8
    v_sub_f32 v8, 1.0, v8
    v_fma_f32 v12, v224, v12, v224
    v_add_f32 v225, 1.0, v9
    v_sub_f32 v9, 1.0, v9
    v_fma_f32 v13, v225, v13, v225
    v_add_f32 v226, 1.0, v10
    v_sub_f32 v10, 1.0, v10
    v_fma_f32 v14, v226, v14, v226
    v_add_f32 v227, 1.0, v11
    v_sub_f32 v11, 1.0, v11
    v_fma_f32 v15, v227, v15, v227
    v_rcp_f32 v12, v12
    v_rcp_f32 v13, v13
    v_rcp_f32 v14, v14
    v_rcp_f32 v15, v15
    v_mul_f32 v8, v8, v12
    v_mul_f32 v9, v9, v13
    v_mul_f32 v10, v10, v14
    v_mul_f32 v11, v11, v15
    v_cvt_pk_bf16_f32 v12, v8, v9
    v_cvt_pk_bf16_f32 v13, v10, v11
    v_min_f32 v104, s40, v104
    v_min_f32 v105, s40, v105
    v_min_f32 v106, s40, v106
    v_min_f32 v107, s40, v107
    v_exp_f32 v104, v104
    v_exp_f32 v108, v108
    v_exp_f32 v105, v105
    v_exp_f32 v109, v109
    v_exp_f32 v106, v106
    v_exp_f32 v110, v110
    v_exp_f32 v107, v107
    v_exp_f32 v111, v111
    v_add_f32 v224, 1.0, v104
    v_sub_f32 v104, 1.0, v104
    v_fma_f32 v108, v224, v108, v224
    v_add_f32 v225, 1.0, v105
    v_sub_f32 v105, 1.0, v105
    v_fma_f32 v109, v225, v109, v225
    v_add_f32 v226, 1.0, v106
    v_sub_f32 v106, 1.0, v106
    v_fma_f32 v110, v226, v110, v226
    v_add_f32 v227, 1.0, v107
    v_sub_f32 v107, 1.0, v107
    v_fma_f32 v111, v227, v111, v227
    v_rcp_f32 v108, v108
    v_rcp_f32 v109, v109
    v_rcp_f32 v110, v110
    v_rcp_f32 v111, v111
    v_mul_f32 v104, v104, v108
    v_mul_f32 v105, v105, v109
    v_mul_f32 v106, v106, v110
    v_mul_f32 v107, v107, v111
    v_cvt_pk_bf16_f32 v14, v104, v105
    v_cvt_pk_bf16_f32 v15, v106, v107
    buffer_store_dwordx4 v[76:79], v247, s[20:23], s37 offen offset:2048 sc1
    buffer_store_dwordx4 v[12:15], v247, s[20:23], s37 offen offset:3072 sc1
    v_mul_f32 v224, s56, v16
    v_fma_f32 v16, s56, v48, v224
    v_fma_f32 v48, -s56, v48, v224
    v_fma_f32 v80, s58, v80, v16
    v_fma_f32 v112, s60, v112, v48
    v_mul_f32 v225, s56, v17
    v_fma_f32 v17, s56, v49, v225
    v_fma_f32 v49, -s56, v49, v225
    v_fma_f32 v81, s58, v81, v17
    v_fma_f32 v113, s60, v113, v49
    v_mul_f32 v226, s56, v18
    v_fma_f32 v18, s56, v50, v226
    v_fma_f32 v50, -s56, v50, v226
    v_fma_f32 v82, s58, v82, v18
    v_fma_f32 v114, s60, v114, v50
    v_mul_f32 v227, s56, v19
    v_fma_f32 v19, s56, v51, v227
    v_fma_f32 v51, -s56, v51, v227
    v_fma_f32 v83, s58, v83, v19
    v_fma_f32 v115, s60, v115, v51
    v_mul_f32 v228, s57, v20
    v_fma_f32 v20, s57, v52, v228
    v_fma_f32 v52, -s57, v52, v228
    v_fma_f32 v84, s59, v84, v20
    v_fma_f32 v116, s61, v116, v52
    v_mul_f32 v229, s57, v21
    v_fma_f32 v21, s57, v53, v229
    v_fma_f32 v53, -s57, v53, v229
    v_fma_f32 v85, s59, v85, v21
    v_fma_f32 v117, s61, v117, v53
    v_mul_f32 v230, s57, v22
    v_fma_f32 v22, s57, v54, v230
    v_fma_f32 v54, -s57, v54, v230
    v_fma_f32 v86, s59, v86, v22
    v_fma_f32 v118, s61, v118, v54
    v_mul_f32 v231, s57, v23
    v_fma_f32 v23, s57, v55, v231
    v_fma_f32 v55, -s57, v55, v231
    v_fma_f32 v87, s59, v87, v23
    v_fma_f32 v119, s61, v119, v55
    v_min_f32 v80, s40, v80
    v_min_f32 v81, s40, v81
    v_min_f32 v82, s40, v82
    v_min_f32 v83, s40, v83
    v_exp_f32 v80, v80
    v_exp_f32 v84, v84
    v_exp_f32 v81, v81
    v_exp_f32 v85, v85
    v_exp_f32 v82, v82
    v_exp_f32 v86, v86
    v_exp_f32 v83, v83
    v_exp_f32 v87, v87
    v_add_f32 v224, 1.0, v80
    v_sub_f32 v80, 1.0, v80
    v_fma_f32 v84, v224, v84, v224
    v_add_f32 v225, 1.0, v81
    v_sub_f32 v81, 1.0, v81
    v_fma_f32 v85, v225, v85, v225
    v_add_f32 v226, 1.0, v82
    v_sub_f32 v82, 1.0, v82
    v_fma_f32 v86, v226, v86, v226
    v_add_f32 v227, 1.0, v83
    v_sub_f32 v83, 1.0, v83
    v_fma_f32 v87, v227, v87, v227
    v_rcp_f32 v84, v84
    v_rcp_f32 v85, v85
    v_rcp_f32 v86, v86
    v_rcp_f32 v87, v87
    v_mul_f32 v80, v80, v84
    v_mul_f32 v81, v81, v85
    v_mul_f32 v82, v82, v86
    v_mul_f32 v83, v83, v87
    v_cvt_pk_bf16_f32 v84, v80, v81
    v_cvt_pk_bf16_f32 v85, v82, v83
    v_min_f32 v48, s40, v48
    v_min_f32 v49, s40, v49
    v_min_f32 v50, s40, v50
    v_min_f32 v51, s40, v51
    v_exp_f32 v48, v48
    v_exp_f32 v52, v52
    v_exp_f32 v49, v49
    v_exp_f32 v53, v53
    v_exp_f32 v50, v50
    v_exp_f32 v54, v54
    v_exp_f32 v51, v51
    v_exp_f32 v55, v55
    v_add_f32 v224, 1.0, v48
    v_sub_f32 v48, 1.0, v48
    v_fma_f32 v52, v224, v52, v224
    v_add_f32 v225, 1.0, v49
    v_sub_f32 v49, 1.0, v49
    v_fma_f32 v53, v225, v53, v225
    v_add_f32 v226, 1.0, v50
    v_sub_f32 v50, 1.0, v50
    v_fma_f32 v54, v226, v54, v226
    v_add_f32 v227, 1.0, v51
    v_sub_f32 v51, 1.0, v51
    v_fma_f32 v55, v227, v55, v227
    v_rcp_f32 v52, v52
    v_rcp_f32 v53, v53
    v_rcp_f32 v54, v54
    v_rcp_f32 v55, v55
    v_mul_f32 v48, v48, v52
    v_mul_f32 v49, v49, v53
    v_mul_f32 v50, v50, v54
    v_mul_f32 v51, v51, v55
    v_cvt_pk_bf16_f32 v86, v48, v49
    v_cvt_pk_bf16_f32 v87, v50, v51
    v_min_f32 v16, s40, v16
    v_min_f32 v17, s40, v17
    v_min_f32 v18, s40, v18
    v_min_f32 v19, s40, v19
    v_exp_f32 v16, v16
    v_exp_f32 v20, v20
    v_exp_f32 v17, v17
    v_exp_f32 v21, v21
    v_exp_f32 v18, v18
    v_exp_f32 v22, v22
    v_exp_f32 v19, v19
    v_exp_f32 v23, v23
    v_add_f32 v224, 1.0, v16
    v_sub_f32 v16, 1.0, v16
    v_fma_f32 v20, v224, v20, v224
    v_add_f32 v225, 1.0, v17
    v_sub_f32 v17, 1.0, v17
    v_fma_f32 v21, v225, v21, v225
    v_add_f32 v226, 1.0, v18
    v_sub_f32 v18, 1.0, v18
    v_fma_f32 v22, v226, v22, v226
    v_add_f32 v227, 1.0, v19
    v_sub_f32 v19, 1.0, v19
    v_fma_f32 v23, v227, v23, v227
    v_rcp_f32 v20, v20
    v_rcp_f32 v21, v21
    v_rcp_f32 v22, v22
    v_rcp_f32 v23, v23
    v_mul_f32 v16, v16, v20
    v_mul_f32 v17, v17, v21
    v_mul_f32 v18, v18, v22
    v_mul_f32 v19, v19, v23
    v_cvt_pk_bf16_f32 v20, v16, v17
    v_cvt_pk_bf16_f32 v21, v18, v19
    v_min_f32 v112, s40, v112
    v_min_f32 v113, s40, v113
    v_min_f32 v114, s40, v114
    v_min_f32 v115, s40, v115
    v_exp_f32 v112, v112
    v_exp_f32 v116, v116
    v_exp_f32 v113, v113
    v_exp_f32 v117, v117
    v_exp_f32 v114, v114
    v_exp_f32 v118, v118
    v_exp_f32 v115, v115
    v_exp_f32 v119, v119
    v_add_f32 v224, 1.0, v112
    v_sub_f32 v112, 1.0, v112
    v_fma_f32 v116, v224, v116, v224
    v_add_f32 v225, 1.0, v113
    v_sub_f32 v113, 1.0, v113
    v_fma_f32 v117, v225, v117, v225
    v_add_f32 v226, 1.0, v114
    v_sub_f32 v114, 1.0, v114
    v_fma_f32 v118, v226, v118, v226
    v_add_f32 v227, 1.0, v115
    v_sub_f32 v115, 1.0, v115
    v_fma_f32 v119, v227, v119, v227
    v_rcp_f32 v116, v116
    v_rcp_f32 v117, v117
    v_rcp_f32 v118, v118
    v_rcp_f32 v119, v119
    v_mul_f32 v112, v112, v116
    v_mul_f32 v113, v113, v117
    v_mul_f32 v114, v114, v118
    v_mul_f32 v115, v115, v119
    v_cvt_pk_bf16_f32 v22, v112, v113
    v_cvt_pk_bf16_f32 v23, v114, v115
    s_lshl_b32 s44, s2, 10
    s_lshl_b32 s45, s28, 7
    s_add_u32 s44, s44, s45
    s_add_u32 s44, s44, 12845056
    v_mov_b32 v253, s44
    v_xor_b32 v251, 8192, v253
    v_mov_b32 v250, 2
    s_waitcnt vmcnt(0)
    s_mov_b64 exec, 1
    buffer_store_dword v250, v251, s[20:23], 0 offen sc1
    s_mov_b64 exec, -1
    v_mul_f32 v224, s56, v24
    v_fma_f32 v24, s56, v56, v224
    v_fma_f32 v56, -s56, v56, v224
    v_fma_f32 v88, s58, v88, v24
    v_fma_f32 v120, s60, v120, v56
    v_mul_f32 v225, s56, v25
    v_fma_f32 v25, s56, v57, v225
    v_fma_f32 v57, -s56, v57, v225
    v_fma_f32 v89, s58, v89, v25
    v_fma_f32 v121, s60, v121, v57
    v_mul_f32 v226, s56, v26
    v_fma_f32 v26, s56, v58, v226
    v_fma_f32 v58, -s56, v58, v226
    v_fma_f32 v90, s58, v90, v26
    v_fma_f32 v122, s60, v122, v58
    v_mul_f32 v227, s56, v27
    v_fma_f32 v27, s56, v59, v227
    v_fma_f32 v59, -s56, v59, v227
    v_fma_f32 v91, s58, v91, v27
    v_fma_f32 v123, s60, v123, v59
    v_mul_f32 v228, s57, v28
    v_fma_f32 v28, s57, v60, v228
    v_fma_f32 v60, -s57, v60, v228
    v_fma_f32 v92, s59, v92, v28
    v_fma_f32 v124, s61, v124, v60
    v_mul_f32 v229, s57, v29
    v_fma_f32 v29, s57, v61, v229
    v_fma_f32 v61, -s57, v61, v229
    v_fma_f32 v93, s59, v93, v29
    v_fma_f32 v125, s61, v125, v61
    v_mul_f32 v230, s57, v30
    v_fma_f32 v30, s57, v62, v230
    v_fma_f32 v62, -s57, v62, v230
    v_fma_f32 v94, s59, v94, v30
    v_fma_f32 v126, s61, v126, v62
    v_mul_f32 v231, s57, v31
    v_fma_f32 v31, s57, v63, v231
    v_fma_f32 v63, -s57, v63, v231
    v_fma_f32 v95, s59, v95, v31
    v_fma_f32 v127, s61, v127, v63
    v_min_f32 v88, s40, v88
    v_min_f32 v89, s40, v89
    v_min_f32 v90, s40, v90
    v_min_f32 v91, s40, v91
    v_exp_f32 v88, v88
    v_exp_f32 v92, v92
    v_exp_f32 v89, v89
    v_exp_f32 v93, v93
    v_exp_f32 v90, v90
    v_exp_f32 v94, v94
    v_exp_f32 v91, v91
    v_exp_f32 v95, v95
    v_add_f32 v224, 1.0, v88
    v_sub_f32 v88, 1.0, v88
    v_fma_f32 v92, v224, v92, v224
    v_add_f32 v225, 1.0, v89
    v_sub_f32 v89, 1.0, v89
    v_fma_f32 v93, v225, v93, v225
    v_add_f32 v226, 1.0, v90
    v_sub_f32 v90, 1.0, v90
    v_fma_f32 v94, v226, v94, v226
    v_add_f32 v227, 1.0, v91
    v_sub_f32 v91, 1.0, v91
    v_fma_f32 v95, v227, v95, v227
    v_rcp_f32 v92, v92
    v_rcp_f32 v93, v93
    v_rcp_f32 v94, v94
    v_rcp_f32 v95, v95
    v_mul_f32 v88, v88, v92
    v_mul_f32 v89, v89, v93
    v_mul_f32 v90, v90, v94
    v_mul_f32 v91, v91, v95
    v_cvt_pk_bf16_f32 v92, v88, v89
    v_cvt_pk_bf16_f32 v93, v90, v91
    v_min_f32 v56, s40, v56
    v_min_f32 v57, s40, v57
    v_min_f32 v58, s40, v58
    v_min_f32 v59, s40, v59
    v_exp_f32 v56, v56
    v_exp_f32 v60, v60
    v_exp_f32 v57, v57
    v_exp_f32 v61, v61
    v_exp_f32 v58, v58
    v_exp_f32 v62, v62
    v_exp_f32 v59, v59
    v_exp_f32 v63, v63
    v_add_f32 v224, 1.0, v56
    v_sub_f32 v56, 1.0, v56
    v_fma_f32 v60, v224, v60, v224
    v_add_f32 v225, 1.0, v57
    v_sub_f32 v57, 1.0, v57
    v_fma_f32 v61, v225, v61, v225
    v_add_f32 v226, 1.0, v58
    v_sub_f32 v58, 1.0, v58
    v_fma_f32 v62, v226, v62, v226
    v_add_f32 v227, 1.0, v59
    v_sub_f32 v59, 1.0, v59
    v_fma_f32 v63, v227, v63, v227
    v_rcp_f32 v60, v60
    v_rcp_f32 v61, v61
    v_rcp_f32 v62, v62
    v_rcp_f32 v63, v63
    v_mul_f32 v56, v56, v60
    v_mul_f32 v57, v57, v61
    v_mul_f32 v58, v58, v62
    v_mul_f32 v59, v59, v63
    v_cvt_pk_bf16_f32 v94, v56, v57
    v_cvt_pk_bf16_f32 v95, v58, v59
    v_min_f32 v24, s40, v24
    v_min_f32 v25, s40, v25
    v_min_f32 v26, s40, v26
    v_min_f32 v27, s40, v27
    v_exp_f32 v24, v24
    v_exp_f32 v28, v28
    v_exp_f32 v25, v25
    v_exp_f32 v29, v29
    v_exp_f32 v26, v26
    v_exp_f32 v30, v30
    v_exp_f32 v27, v27
    v_exp_f32 v31, v31
    v_add_f32 v224, 1.0, v24
    v_sub_f32 v24, 1.0, v24
    v_fma_f32 v28, v224, v28, v224
    v_add_f32 v225, 1.0, v25
    v_sub_f32 v25, 1.0, v25
    v_fma_f32 v29, v225, v29, v225
    v_add_f32 v226, 1.0, v26
    v_sub_f32 v26, 1.0, v26
    v_fma_f32 v30, v226, v30, v226
    v_add_f32 v227, 1.0, v27
    v_sub_f32 v27, 1.0, v27
    v_fma_f32 v31, v227, v31, v227
    v_rcp_f32 v28, v28
    v_rcp_f32 v29, v29
    v_rcp_f32 v30, v30
    v_rcp_f32 v31, v31
    v_mul_f32 v24, v24, v28
    v_mul_f32 v25, v25, v29
    v_mul_f32 v26, v26, v30
    v_mul_f32 v27, v27, v31
    v_cvt_pk_bf16_f32 v28, v24, v25
    v_cvt_pk_bf16_f32 v29, v26, v27
    v_min_f32 v120, s40, v120
    v_min_f32 v121, s40, v121
    v_min_f32 v122, s40, v122
    v_min_f32 v123, s40, v123
    v_exp_f32 v120, v120
    v_exp_f32 v124, v124
    v_exp_f32 v121, v121
    v_exp_f32 v125, v125
    v_exp_f32 v122, v122
    v_exp_f32 v126, v126
    v_exp_f32 v123, v123
    v_exp_f32 v127, v127
    v_add_f32 v224, 1.0, v120
    v_sub_f32 v120, 1.0, v120
    v_fma_f32 v124, v224, v124, v224
    v_add_f32 v225, 1.0, v121
    v_sub_f32 v121, 1.0, v121
    v_fma_f32 v125, v225, v125, v225
    v_add_f32 v226, 1.0, v122
    v_sub_f32 v122, 1.0, v122
    v_fma_f32 v126, v226, v126, v226
    v_add_f32 v227, 1.0, v123
    v_sub_f32 v123, 1.0, v123
    v_fma_f32 v127, v227, v127, v227
    v_rcp_f32 v124, v124
    v_rcp_f32 v125, v125
    v_rcp_f32 v126, v126
    v_rcp_f32 v127, v127
    v_mul_f32 v120, v120, v124
    v_mul_f32 v121, v121, v125
    v_mul_f32 v122, v122, v126
    v_mul_f32 v123, v123, v127
    v_cvt_pk_bf16_f32 v30, v120, v121
    v_cvt_pk_bf16_f32 v31, v122, v123
    s_barrier
    ds_write2st64_b64 v222, v[84:85], v[86:87] offset0:0 offset1:16
    ds_write2st64_b64 v222, v[20:21], v[22:23] offset0:32 offset1:48
    ds_write2st64_b64 v222, v[92:93], v[94:95] offset0:64 offset1:80
    ds_write2st64_b64 v222, v[28:29], v[30:31] offset0:96 offset1:112
    buffer_load_dword v252, v253, s[20:23], 0 offen sc1
    s_waitcnt lgkmcnt(0)
    s_barrier
    ds_read_b128 v[192:195], v247 offset:0
    ds_read_b128 v[196:199], v247 offset:8192
    ds_read_b128 v[200:203], v247 offset:16384
    ds_read_b128 v[204:207], v247 offset:24576
    ds_read_b128 v[224:227], v247 offset:32768
    ds_read_b128 v[228:231], v247 offset:40960
    ds_read_b128 v[232:235], v247 offset:49152
    ds_read_b128 v[236:239], v247 offset:57344
    s_waitcnt lgkmcnt(7)
    v_mfma_f32_16x16x32_bf16 v[0:3], v[128:131], v[192:195], 0
    v_mfma_f32_16x16x32_bf16 v[4:7], v[132:135], v[192:195], 0
    ds_read_b128 v[192:195], v247 offset:1024
    s_waitcnt lgkmcnt(7)
    v_mfma_f32_16x16x32_bf16 v[8:11], v[128:131], v[196:199], 0
    v_mfma_f32_16x16x32_bf16 v[12:15], v[132:135], v[196:199], 0
    ds_read_b128 v[196:199], v247 offset:9216
    s_waitcnt lgkmcnt(7)
    v_mfma_f32_16x16x32_bf16 v[32:35], v[128:131], v[200:203], 0
    v_mfma_f32_16x16x32_bf16 v[36:39], v[132:135], v[200:203], 0
    ds_read_b128 v[200:203], v247 offset:17408
    s_waitcnt lgkmcnt(7)
    v_mfma_f32_16x16x32_bf16 v[40:43], v[128:131], v[204:207], 0
    v_mfma_f32_16x16x32_bf16 v[44:47], v[132:135], v[204:207], 0
    ds_read_b128 v[204:207], v247 offset:25600
    s_waitcnt lgkmcnt(7)
    v_mfma_f32_16x16x32_bf16 v[64:67], v[128:131], v[224:227], 0
    v_mfma_f32_16x16x32_bf16 v[68:71], v[132:135], v[224:227], 0
    ds_read_b128 v[224:227], v247 offset:33792
    s_waitcnt lgkmcnt(7)
    v_mfma_f32_16x16x32_bf16 v[72:75], v[128:131], v[228:231], 0
    v_mfma_f32_16x16x32_bf16 v[76:79], v[132:135], v[228:231], 0
    ds_read_b128 v[228:231], v247 offset:41984
    s_waitcnt lgkmcnt(7)
    v_mfma_f32_16x16x32_bf16 v[96:99], v[128:131], v[232:235], 0
    v_mfma_f32_16x16x32_bf16 v[100:103], v[132:135], v[232:235], 0
    ds_read_b128 v[232:235], v247 offset:50176
    s_waitcnt lgkmcnt(7)
    v_mfma_f32_16x16x32_bf16 v[104:107], v[128:131], v[236:239], 0
    v_mfma_f32_16x16x32_bf16 v[108:111], v[132:135], v[236:239], 0
    ds_read_b128 v[236:239], v247 offset:58368
    s_waitcnt lgkmcnt(7)
    v_mfma_f32_16x16x32_bf16 v[0:3], v[136:139], v[192:195], v[0:3]
    v_mfma_f32_16x16x32_bf16 v[4:7], v[140:143], v[192:195], v[4:7]
    ds_read_b128 v[192:195], v247 offset:2048
    s_waitcnt lgkmcnt(7)
    v_mfma_f32_16x16x32_bf16 v[8:11], v[136:139], v[196:199], v[8:11]
    v_mfma_f32_16x16x32_bf16 v[12:15], v[140:143], v[196:199], v[12:15]
    ds_read_b128 v[196:199], v247 offset:10240
    s_waitcnt lgkmcnt(7)
    v_mfma_f32_16x16x32_bf16 v[32:35], v[136:139], v[200:203], v[32:35]
    v_mfma_f32_16x16x32_bf16 v[36:39], v[140:143], v[200:203], v[36:39]
    ds_read_b128 v[200:203], v247 offset:18432
    s_mov_b32 s39, 0
    s_waitcnt vmcnt(0)
    v_readfirstlane_b32 s44, v252
    s_cmp_eq_u32 s44, 2
    s_cbranch_scc1 L_ZH10_Y
    buffer_load_dword v252, v253, s[20:23], 0 offen sc1
    s_branch L_ZH10
L_ZH10_Y:
    buffer_load_dwordx4 v[16:19], v247, s[20:23], s36 offen offset:0 sc1
    buffer_load_dwordx4 v[20:23], v247, s[20:23], s36 offen offset:1024 sc1
    buffer_load_dwordx4 v[24:27], v247, s[20:23], s36 offen offset:2048 sc1
    buffer_load_dwordx4 v[28:31], v247, s[20:23], s36 offen offset:3072 sc1
    s_mov_b32 s39, 1
L_ZH10:
    s_waitcnt lgkmcnt(7)
    v_mfma_f32_16x16x32_bf16 v[40:43], v[136:139], v[204:207], v[40:43]
    v_mfma_f32_16x16x32_bf16 v[44:47], v[140:143], v[204:207], v[44:47]
    ds_read_b128 v[204:207], v247 offset:26624
    s_waitcnt lgkmcnt(7)
    v_mfma_f32_16x16x32_bf16 v[64:67], v[136:139], v[224:227], v[64:67]
    v_mfma_f32_16x16x32_bf16 v[68:71], v[140:143], v[224:227], v[68:71]
    ds_read_b128 v[224:227], v247 offset:34816
    s_waitcnt lgkmcnt(7)
    v_mfma_f32_16x16x32_bf16 v[72:75], v[136:139], v[228:231], v[72:75]
    v_mfma_f32_16x16x32_bf16 v[76:79], v[140:143], v[228:231], v[76:79]
    ds_read_b128 v[228:231], v247 offset:43008
    s_waitcnt lgkmcnt(7)
    v_mfma_f32_16x16x32_bf16 v[96:99], v[136:139], v[232:235], v[96:99]
    v_mfma_f32_16x16x32_bf16 v[100:103], v[140:143], v[232:235], v[100:103]
    ds_read_b128 v[232:235], v247 offset:51200
    s_waitcnt lgkmcnt(7)
    v_mfma_f32_16x16x32_bf16 v[104:107], v[136:139], v[236:239], v[104:107]
    v_mfma_f32_16x16x32_bf16 v[108:111], v[140:143], v[236:239], v[108:111]
    ds_read_b128 v[236:239], v247 offset:59392
    s_waitcnt lgkmcnt(7)
    v_mfma_f32_16x16x32_bf16 v[0:3], v[144:147], v[192:195], v[0:3]
    v_mfma_f32_16x16x32_bf16 v[4:7], v[148:151], v[192:195], v[4:7]
    ds_read_b128 v[192:195], v247 offset:3072
    s_waitcnt lgkmcnt(7)
    v_mfma_f32_16x16x32_bf16 v[8:11], v[144:147], v[196:199], v[8:11]
    v_mfma_f32_16x16x32_bf16 v[12:15], v[148:151], v[196:199], v[12:15]
    ds_read_b128 v[196:199], v247 offset:11264
    s_waitcnt lgkmcnt(7)
    v_mfma_f32_16x16x32_bf16 v[32:35], v[144:147], v[200:203], v[32:35]
    v_mfma_f32_16x16x32_bf16 v[36:39], v[148:151], v[200:203], v[36:39]
    ds_read_b128 v[200:203], v247 offset:19456
    s_waitcnt lgkmcnt(7)
    v_mfma_f32_16x16x32_bf16 v[40:43], v[144:147], v[204:207], v[40:43]
    v_mfma_f32_16x16x32_bf16 v[44:47], v[148:151], v[204:207], v[44:47]
    ds_read_b128 v[204:207], v247 offset:27648
    s_waitcnt lgkmcnt(7)
    v_mfma_f32_16x16x32_bf16 v[64:67], v[144:147], v[224:227], v[64:67]
    v_mfma_f32_16x16x32_bf16 v[68:71], v[148:151], v[224:227], v[68:71]
    ds_read_b128 v[224:227], v247 offset:35840
    s_cmp_lg_u32 s39, 0
    s_cbranch_scc1 L_ZH20
    s_waitcnt vmcnt(0)
    v_readfirstlane_b32 s44, v252
    s_cmp_eq_u32 s44, 2
    s_cbranch_scc1 L_ZH20_Y
    buffer_load_dword v252, v253, s[20:23], 0 offen sc1
    s_branch L_ZH20
L_ZH20_Y:
    buffer_load_dwordx4 v[16:19], v247, s[20:23], s36 offen offset:0 sc1
    buffer_load_dwordx4 v[20:23], v247, s[20:23], s36 offen offset:1024 sc1
    buffer_load_dwordx4 v[24:27], v247, s[20:23], s36 offen offset:2048 sc1
    buffer_load_dwordx4 v[28:31], v247, s[20:23], s36 offen offset:3072 sc1
    s_mov_b32 s39, 1
L_ZH20:
    s_waitcnt lgkmcnt(7)
    v_mfma_f32_16x16x32_bf16 v[72:75], v[144:147], v[228:231], v[72:75]
    v_mfma_f32_16x16x32_bf16 v[76:79], v[148:151], v[228:231], v[76:79]
    ds_read_b128 v[228:231], v247 offset:44032
    s_waitcnt lgkmcnt(7)
    v_mfma_f32_16x16x32_bf16 v[96:99], v[144:147], v[232:235], v[96:99]
    v_mfma_f32_16x16x32_bf16 v[100:103], v[148:151], v[232:235], v[100:103]
    ds_read_b128 v[232:235], v247 offset:52224
    s_waitcnt lgkmcnt(7)
    v_mfma_f32_16x16x32_bf16 v[104:107], v[144:147], v[236:239], v[104:107]
    v_mfma_f32_16x16x32_bf16 v[108:111], v[148:151], v[236:239], v[108:111]
    ds_read_b128 v[236:239], v247 offset:60416
    s_waitcnt lgkmcnt(7)
    v_mfma_f32_16x16x32_bf16 v[0:3], v[152:155], v[192:195], v[0:3]
    v_mfma_f32_16x16x32_bf16 v[4:7], v[156:159], v[192:195], v[4:7]
    s_waitcnt lgkmcnt(6)
    v_mfma_f32_16x16x32_bf16 v[8:11], v[152:155], v[196:199], v[8:11]
    v_mfma_f32_16x16x32_bf16 v[12:15], v[156:159], v[196:199], v[12:15]
    s_waitcnt lgkmcnt(5)
    v_mfma_f32_16x16x32_bf16 v[32:35], v[152:155], v[200:203], v[32:35]
    v_mfma_f32_16x16x32_bf16 v[36:39], v[156:159], v[200:203], v[36:39]
    s_waitcnt lgkmcnt(4)
    v_mfma_f32_16x16x32_bf16 v[40:43], v[152:155], v[204:207], v[40:43]
    v_mfma_f32_16x16x32_bf16 v[44:47], v[156:159], v[204:207], v[44:47]
    s_waitcnt lgkmcnt(3)
    v_mfma_f32_16x16x32_bf16 v[64:67], v[152:155], v[224:227], v[64:67]
    v_mfma_f32_16x16x32_bf16 v[68:71], v[156:159], v[224:227], v[68:71]
    s_waitcnt lgkmcnt(2)
    v_mfma_f32_16x16x32_bf16 v[72:75], v[152:155], v[228:231], v[72:75]
    v_mfma_f32_16x16x32_bf16 v[76:79], v[156:159], v[228:231], v[76:79]
    s_waitcnt lgkmcnt(1)
    v_mfma_f32_16x16x32_bf16 v[96:99], v[152:155], v[232:235], v[96:99]
    v_mfma_f32_16x16x32_bf16 v[100:103], v[156:159], v[232:235], v[100:103]
    s_waitcnt lgkmcnt(0)
    v_mfma_f32_16x16x32_bf16 v[104:107], v[152:155], v[236:239], v[104:107]
    v_mfma_f32_16x16x32_bf16 v[108:111], v[156:159], v[236:239], v[108:111]
    s_cmp_lg_u32 s39, 0
    s_cbranch_scc1 L_POLLED
    s_mov_b32 s45, 0
L_POLL:
    s_waitcnt vmcnt(0)
    v_readfirstlane_b32 s44, v252
    s_add_u32 s45, s45, 1
    s_cmp_eq_u32 s44, 2
    s_cbranch_scc1 L_POLLY
    buffer_load_dword v252, v253, s[20:23], 0 offen sc1
    s_cmp_lt_u32 s45, 100000
    s_cbranch_scc1 L_POLL
L_POLLY:
    buffer_load_dwordx4 v[16:19], v247, s[20:23], s36 offen offset:0 sc1
    buffer_load_dwordx4 v[20:23], v247, s[20:23], s36 offen offset:1024 sc1
    buffer_load_dwordx4 v[24:27], v247, s[20:23], s36 offen offset:2048 sc1
    buffer_load_dwordx4 v[28:31], v247, s[20:23], s36 offen offset:3072 sc1
L_POLLED:
    s_waitcnt vmcnt(0)
    ds_write2st64_b64 v222, v[16:17], v[18:19] offset0:8 offset1:24
    ds_write2st64_b64 v222, v[20:21], v[22:23] offset0:40 offset1:56
    ds_write2st64_b64 v222, v[24:25], v[26:27] offset0:72 offset1:88
    ds_write2st64_b64 v222, v[28:29], v[30:31] offset0:104 offset1:120
    s_waitcnt lgkmcnt(0)
    s_barrier
    ds_read_b128 v[192:195], v247 offset:4096
    ds_read_b128 v[196:199], v247 offset:12288
    ds_read_b128 v[200:203], v247 offset:20480
    ds_read_b128 v[204:207], v247 offset:28672
    ds_read_b128 v[224:227], v247 offset:36864
    ds_read_b128 v[228:231], v247 offset:45056
    ds_read_b128 v[232:235], v247 offset:53248
    ds_read_b128 v[236:239], v247 offset:61440
    s_waitcnt lgkmcnt(7)
    v_mfma_f32_16x16x32_bf16 v[0:3], v[160:163], v[192:195], v[0:3]
    v_mfma_f32_16x16x32_bf16 v[4:7], v[164:167], v[192:195], v[4:7]
    ds_read_b128 v[192:195], v247 offset:5120
    s_waitcnt lgkmcnt(7)
    v_mfma_f32_16x16x32_bf16 v[8:11], v[160:163], v[196:199], v[8:11]
    v_mfma_f32_16x16x32_bf16 v[12:15], v[164:167], v[196:199], v[12:15]
    ds_read_b128 v[196:199], v247 offset:13312
    s_waitcnt lgkmcnt(7)
    v_mfma_f32_16x16x32_bf16 v[32:35], v[160:163], v[200:203], v[32:35]
    v_mfma_f32_16x16x32_bf16 v[36:39], v[164:167], v[200:203], v[36:39]
    ds_read_b128 v[200:203], v247 offset:21504
    s_waitcnt lgkmcnt(7)
    v_mfma_f32_16x16x32_bf16 v[40:43], v[160:163], v[204:207], v[40:43]
    v_mfma_f32_16x16x32_bf16 v[44:47], v[164:167], v[204:207], v[44:47]
    ds_read_b128 v[204:207], v247 offset:29696
    s_waitcnt lgkmcnt(7)
    v_mfma_f32_16x16x32_bf16 v[64:67], v[160:163], v[224:227], v[64:67]
    v_mfma_f32_16x16x32_bf16 v[68:71], v[164:167], v[224:227], v[68:71]
    ds_read_b128 v[224:227], v247 offset:37888
    s_waitcnt lgkmcnt(7)
    v_mfma_f32_16x16x32_bf16 v[72:75], v[160:163], v[228:231], v[72:75]
    v_mfma_f32_16x16x32_bf16 v[76:79], v[164:167], v[228:231], v[76:79]
    ds_read_b128 v[228:231], v247 offset:46080
    s_waitcnt lgkmcnt(7)
    v_mfma_f32_16x16x32_bf16 v[96:99], v[160:163], v[232:235], v[96:99]
    v_mfma_f32_16x16x32_bf16 v[100:103], v[164:167], v[232:235], v[100:103]
    ds_read_b128 v[232:235], v247 offset:54272
    s_waitcnt lgkmcnt(7)
    v_mfma_f32_16x16x32_bf16 v[104:107], v[160:163], v[236:239], v[104:107]
    v_mfma_f32_16x16x32_bf16 v[108:111], v[164:167], v[236:239], v[108:111]
    ds_read_b128 v[236:239], v247 offset:62464
    s_waitcnt lgkmcnt(7)
    v_mfma_f32_16x16x32_bf16 v[0:3], v[168:171], v[192:195], v[0:3]
    v_mfma_f32_16x16x32_bf16 v[4:7], v[172:175], v[192:195], v[4:7]
    ds_read_b128 v[192:195], v247 offset:6144
    s_waitcnt lgkmcnt(7)
    v_mfma_f32_16x16x32_bf16 v[8:11], v[168:171], v[196:199], v[8:11]
    v_mfma_f32_16x16x32_bf16 v[12:15], v[172:175], v[196:199], v[12:15]
    ds_read_b128 v[196:199], v247 offset:14336
    s_waitcnt lgkmcnt(7)
    v_mfma_f32_16x16x32_bf16 v[32:35], v[168:171], v[200:203], v[32:35]
    v_mfma_f32_16x16x32_bf16 v[36:39], v[172:175], v[200:203], v[36:39]
    ds_read_b128 v[200:203], v247 offset:22528
    s_waitcnt lgkmcnt(7)
    v_mfma_f32_16x16x32_bf16 v[40:43], v[168:171], v[204:207], v[40:43]
    v_mfma_f32_16x16x32_bf16 v[44:47], v[172:175], v[204:207], v[44:47]
    ds_read_b128 v[204:207], v247 offset:30720
    s_waitcnt lgkmcnt(7)
    v_mfma_f32_16x16x32_bf16 v[64:67], v[168:171], v[224:227], v[64:67]
    v_mfma_f32_16x16x32_bf16 v[68:71], v[172:175], v[224:227], v[68:71]
    ds_read_b128 v[224:227], v247 offset:38912
    s_waitcnt lgkmcnt(7)
    v_mfma_f32_16x16x32_bf16 v[72:75], v[168:171], v[228:231], v[72:75]
    v_mfma_f32_16x16x32_bf16 v[76:79], v[172:175], v[228:231], v[76:79]
    ds_read_b128 v[228:231], v247 offset:47104
    s_waitcnt lgkmcnt(7)
    v_mfma_f32_16x16x32_bf16 v[96:99], v[168:171], v[232:235], v[96:99]
    v_mfma_f32_16x16x32_bf16 v[100:103], v[172:175], v[232:235], v[100:103]
    ds_read_b128 v[232:235], v247 offset:55296
    s_waitcnt lgkmcnt(7)
    v_mfma_f32_16x16x32_bf16 v[104:107], v[168:171], v[236:239], v[104:107]
    v_mfma_f32_16x16x32_bf16 v[108:111], v[172:175], v[236:239], v[108:111]
    ds_read_b128 v[236:239], v247 offset:63488
    s_waitcnt lgkmcnt(7)
    v_mfma_f32_16x16x32_bf16 v[0:3], v[176:179], v[192:195], v[0:3]
    v_mfma_f32_16x16x32_bf16 v[4:7], v[180:183], v[192:195], v[4:7]
    ds_read_b128 v[192:195], v247 offset:7168
    s_waitcnt lgkmcnt(7)
    v_mfma_f32_16x16x32_bf16 v[8:11], v[176:179], v[196:199], v[8:11]
    v_mfma_f32_16x16x32_bf16 v[12:15], v[180:183], v[196:199], v[12:15]
    ds_read_b128 v[196:199], v247 offset:15360
    s_waitcnt lgkmcnt(7)
    v_mfma_f32_16x16x32_bf16 v[32:35], v[176:179], v[200:203], v[32:35]
    v_mfma_f32_16x16x32_bf16 v[36:39], v[180:183], v[200:203], v[36:39]
    ds_read_b128 v[200:203], v247 offset:23552
    s_waitcnt lgkmcnt(7)
    v_mfma_f32_16x16x32_bf16 v[40:43], v[176:179], v[204:207], v[40:43]
    v_mfma_f32_16x16x32_bf16 v[44:47], v[180:183], v[204:207], v[44:47]
    ds_read_b128 v[204:207], v247 offset:31744
    s_waitcnt lgkmcnt(7)
    v_mfma_f32_16x16x32_bf16 v[64:67], v[176:179], v[224:227], v[64:67]
    v_mfma_f32_16x16x32_bf16 v[68:71], v[180:183], v[224:227], v[68:71]
    ds_read_b128 v[224:227], v247 offset:39936
    s_waitcnt lgkmcnt(7)
    v_mfma_f32_16x16x32_bf16 v[72:75], v[176:179], v[228:231], v[72:75]
    v_mfma_f32_16x16x32_bf16 v[76:79], v[180:183], v[228:231], v[76:79]
    ds_read_b128 v[228:231], v247 offset:48128
    s_waitcnt lgkmcnt(7)
    v_mfma_f32_16x16x32_bf16 v[96:99], v[176:179], v[232:235], v[96:99]
    v_mfma_f32_16x16x32_bf16 v[100:103], v[180:183], v[232:235], v[100:103]
    ds_read_b128 v[232:235], v247 offset:56320
    s_waitcnt lgkmcnt(7)
    v_mfma_f32_16x16x32_bf16 v[104:107], v[176:179], v[236:239], v[104:107]
    v_mfma_f32_16x16x32_bf16 v[108:111], v[180:183], v[236:239], v[108:111]
    ds_read_b128 v[236:239], v247 offset:64512
    s_waitcnt lgkmcnt(7)
    v_mfma_f32_16x16x32_bf16 v[0:3], v[184:187], v[192:195], v[0:3]
    v_mfma_f32_16x16x32_bf16 v[4:7], v[188:191], v[192:195], v[4:7]
    s_waitcnt lgkmcnt(6)
    v_mfma_f32_16x16x32_bf16 v[8:11], v[184:187], v[196:199], v[8:11]
    v_mfma_f32_16x16x32_bf16 v[12:15], v[188:191], v[196:199], v[12:15]
    s_waitcnt lgkmcnt(5)
    v_mfma_f32_16x16x32_bf16 v[32:35], v[184:187], v[200:203], v[32:35]
    v_mfma_f32_16x16x32_bf16 v[36:39], v[188:191], v[200:203], v[36:39]
    s_waitcnt lgkmcnt(4)
    v_mfma_f32_16x16x32_bf16 v[40:43], v[184:187], v[204:207], v[40:43]
    v_mfma_f32_16x16x32_bf16 v[44:47], v[188:191], v[204:207], v[44:47]
    s_waitcnt lgkmcnt(3)
    v_mfma_f32_16x16x32_bf16 v[64:67], v[184:187], v[224:227], v[64:67]
    v_mfma_f32_16x16x32_bf16 v[68:71], v[188:191], v[224:227], v[68:71]
    s_waitcnt lgkmcnt(2)
    v_mfma_f32_16x16x32_bf16 v[72:75], v[184:187], v[228:231], v[72:75]
    v_mfma_f32_16x16x32_bf16 v[76:79], v[188:191], v[228:231], v[76:79]
    s_waitcnt lgkmcnt(1)
    v_mfma_f32_16x16x32_bf16 v[96:99], v[184:187], v[232:235], v[96:99]
    v_mfma_f32_16x16x32_bf16 v[100:103], v[188:191], v[232:235], v[100:103]
    s_waitcnt lgkmcnt(0)
    v_mfma_f32_16x16x32_bf16 v[104:107], v[184:187], v[236:239], v[104:107]
    v_mfma_f32_16x16x32_bf16 v[108:111], v[188:191], v[236:239], v[108:111]
    v_cvt_pk_bf16_f32 v0, v0, v1
    v_cvt_pk_bf16_f32 v1, v2, v3
    v_cvt_pk_bf16_f32 v2, v4, v5
    v_cvt_pk_bf16_f32 v3, v6, v7
    s_mov_b32 s44, 0
    buffer_store_dwordx4 v[0:3], v223, s[16:19], s44 offen offset:0 sc0 sc1
    v_cvt_pk_bf16_f32 v8, v8, v9
    v_cvt_pk_bf16_f32 v9, v10, v11
    v_cvt_pk_bf16_f32 v10, v12, v13
    v_cvt_pk_bf16_f32 v11, v14, v15
    buffer_store_dwordx4 v[8:11], v223, s[16:19], s44 offen offset:1024 sc0 sc1
    v_cvt_pk_bf16_f32 v32, v32, v33
    v_cvt_pk_bf16_f32 v33, v34, v35
    v_cvt_pk_bf16_f32 v34, v36, v37
    v_cvt_pk_bf16_f32 v35, v38, v39
    buffer_store_dwordx4 v[32:35], v223, s[16:19], s44 offen offset:2048 sc0 sc1
    v_cvt_pk_bf16_f32 v40, v40, v41
    v_cvt_pk_bf16_f32 v41, v42, v43
    v_cvt_pk_bf16_f32 v42, v44, v45
    v_cvt_pk_bf16_f32 v43, v46, v47
    buffer_store_dwordx4 v[40:43], v223, s[16:19], s44 offen offset:3072 sc0 sc1
    v_cvt_pk_bf16_f32 v64, v64, v65
    v_cvt_pk_bf16_f32 v65, v66, v67
    v_cvt_pk_bf16_f32 v66, v68, v69
    v_cvt_pk_bf16_f32 v67, v70, v71
    s_mov_b32 s44, 32768
    buffer_store_dwordx4 v[64:67], v223, s[16:19], s44 offen offset:0 sc0 sc1
    v_cvt_pk_bf16_f32 v72, v72, v73
    v_cvt_pk_bf16_f32 v73, v74, v75
    v_cvt_pk_bf16_f32 v74, v76, v77
    v_cvt_pk_bf16_f32 v75, v78, v79
    buffer_store_dwordx4 v[72:75], v223, s[16:19], s44 offen offset:1024 sc0 sc1
    v_cvt_pk_bf16_f32 v96, v96, v97
    v_cvt_pk_bf16_f32 v97, v98, v99
    v_cvt_pk_bf16_f32 v98, v100, v101
    v_cvt_pk_bf16_f32 v99, v102, v103
    buffer_store_dwordx4 v[96:99], v223, s[16:19], s44 offen offset:2048 sc0 sc1
    v_cvt_pk_bf16_f32 v104, v104, v105
    v_cvt_pk_bf16_f32 v105, v106, v107
    v_cvt_pk_bf16_f32 v106, v108, v109
    v_cvt_pk_bf16_f32 v107, v110, v111
    buffer_store_dwordx4 v[104:107], v223, s[16:19], s44 offen offset:3072 sc0 sc1
L_END:
    s_endpgm
L_RS1:
    s_nop 7
    s_nop 7
    v_readlane_b32 s44, v255, 1
    v_readlane_b32 s45, v255, 9
    s_add_i32 s44, s44, 127
    s_lshl_b32 s44, s44, 23
    s_add_i32 s45, s45, 127
    s_lshl_b32 s45, s45, 23
    v_mul_f32 v0, s44, v0
    v_mul_f32 v1, s44, v1
    v_mul_f32 v2, s44, v2
    v_mul_f32 v3, s44, v3
    v_mul_f32 v4, s45, v4
    v_mul_f32 v5, s45, v5
    v_mul_f32 v6, s45, v6
    v_mul_f32 v7, s45, v7
    v_mul_f32 v8, s44, v8
    v_mul_f32 v9, s44, v9
    v_mul_f32 v10, s44, v10
    v_mul_f32 v11, s44, v11
    v_mul_f32 v12, s45, v12
    v_mul_f32 v13, s45, v13
    v_mul_f32 v14, s45, v14
    v_mul_f32 v15, s45, v15
    v_mul_f32 v16, s44, v16
    v_mul_f32 v17, s44, v17
    v_mul_f32 v18, s44, v18
    v_mul_f32 v19, s44, v19
    v_mul_f32 v20, s45, v20
    v_mul_f32 v21, s45, v21
    v_mul_f32 v22, s45, v22
    v_mul_f32 v23, s45, v23
    v_mul_f32 v24, s44, v24
    v_mul_f32 v25, s44, v25
    v_mul_f32 v26, s44, v26
    v_mul_f32 v27, s44, v27
    v_mul_f32 v28, s45, v28
    v_mul_f32 v29, s45, v29
    v_mul_f32 v30, s45, v30
    v_mul_f32 v31, s45, v31
    v_mul_f32 v32, s44, v32
    v_mul_f32 v33, s44, v33
    v_mul_f32 v34, s44, v34
    v_mul_f32 v35, s44, v35
    v_mul_f32 v36, s45, v36
    v_mul_f32 v37, s45, v37
    v_mul_f32 v38, s45, v38
    v_mul_f32 v39, s45, v39
    v_mul_f32 v40, s44, v40
    v_mul_f32 v41, s44, v41
    v_mul_f32 v42, s44, v42
    v_mul_f32 v43, s44, v43
    v_mul_f32 v44, s45, v44
    v_mul_f32 v45, s45, v45
    v_mul_f32 v46, s45, v46
    v_mul_f32 v47, s45, v47
    v_mul_f32 v48, s44, v48
    v_mul_f32 v49, s44, v49
    v_mul_f32 v50, s44, v50
    v_mul_f32 v51, s44, v51
    v_mul_f32 v52, s45, v52
    v_mul_f32 v53, s45, v53
    v_mul_f32 v54, s45, v54
    v_mul_f32 v55, s45, v55
    v_mul_f32 v56, s44, v56
    v_mul_f32 v57, s44, v57
    v_mul_f32 v58, s44, v58
    v_mul_f32 v59, s44, v59
    v_mul_f32 v60, s45, v60
    v_mul_f32 v61, s45, v61
    v_mul_f32 v62, s45, v62
    v_mul_f32 v63, s45, v63
    v_mul_f32 v64, s44, v64
    v_mul_f32 v65, s44, v65
    v_mul_f32 v66, s44, v66
    v_mul_f32 v67, s44, v67
    v_mul_f32 v68, s45, v68
    v_mul_f32 v69, s45, v69
    v_mul_f32 v70, s45, v70
    v_mul_f32 v71, s45, v71
    v_mul_f32 v72, s44, v72
    v_mul_f32 v73, s44, v73
    v_mul_f32 v74, s44, v74
    v_mul_f32 v75, s44, v75
    v_mul_f32 v76, s45, v76
    v_mul_f32 v77, s45, v77
    v_mul_f32 v78, s45, v78
    v_mul_f32 v79, s45, v79
    v_mul_f32 v80, s44, v80
    v_mul_f32 v81, s44, v81
    v_mul_f32 v82, s44, v82
    v_mul_f32 v83, s44, v83
    v_mul_f32 v84, s45, v84
    v_mul_f32 v85, s45, v85
    v_mul_f32 v86, s45, v86
    v_mul_f32 v87, s45, v87
    v_mul_f32 v88, s44, v88
    v_mul_f32 v89, s44, v89
    v_mul_f32 v90, s44, v90
    v_mul_f32 v91, s44, v91
    v_mul_f32 v92, s45, v92
    v_mul_f32 v93, s45, v93
    v_mul_f32 v94, s45, v94
    v_mul_f32 v95, s45, v95
    v_mul_f32 v96, s44, v96
    v_mul_f32 v97, s44, v97
    v_mul_f32 v98, s44, v98
    v_mul_f32 v99, s44, v99
    v_mul_f32 v100, s45, v100
    v_mul_f32 v101, s45, v101
    v_mul_f32 v102, s45, v102
    v_mul_f32 v103, s45, v103
    v_mul_f32 v104, s44, v104
    v_mul_f32 v105, s44, v105
    v_mul_f32 v106, s44, v106
    v_mul_f32 v107, s44, v107
    v_mul_f32 v108, s45, v108
    v_mul_f32 v109, s45, v109
    v_mul_f32 v110, s45, v110
    v_mul_f32 v111, s45, v111
    v_mul_f32 v112, s44, v112
    v_mul_f32 v113, s44, v113
    v_mul_f32 v114, s44, v114
    v_mul_f32 v115, s44, v115
    v_mul_f32 v116, s45, v116
    v_mul_f32 v117, s45, v117
    v_mul_f32 v118, s45, v118
    v_mul_f32 v119, s45, v119
    v_mul_f32 v120, s44, v120
    v_mul_f32 v121, s44, v121
    v_mul_f32 v122, s44, v122
    v_mul_f32 v123, s44, v123
    v_mul_f32 v124, s45, v124
    v_mul_f32 v125, s45, v125
    v_mul_f32 v126, s45, v126
    v_mul_f32 v127, s45, v127
    s_nop 7
    s_branch L_RB1
L_RS2:
    s_nop 7
    s_nop 7
    v_readlane_b32 s44, v255, 2
    v_readlane_b32 s45, v255, 10
    s_add_i32 s44, s44, 127
    s_lshl_b32 s44, s44, 23
    s_add_i32 s45, s45, 127
    s_lshl_b32 s45, s45, 23
    v_mul_f32 v0, s44, v0
    v_mul_f32 v1, s44, v1
    v_mul_f32 v2, s44, v2
    v_mul_f32 v3, s44, v3
    v_mul_f32 v4, s45, v4
    v_mul_f32 v5, s45, v5
    v_mul_f32 v6, s45, v6
    v_mul_f32 v7, s45, v7
    v_mul_f32 v8, s44, v8
    v_mul_f32 v9, s44, v9
    v_mul_f32 v10, s44, v10
    v_mul_f32 v11, s44, v11
    v_mul_f32 v12, s45, v12
    v_mul_f32 v13, s45, v13
    v_mul_f32 v14, s45, v14
    v_mul_f32 v15, s45, v15
    v_mul_f32 v16, s44, v16
    v_mul_f32 v17, s44, v17
    v_mul_f32 v18, s44, v18
    v_mul_f32 v19, s44, v19
    v_mul_f32 v20, s45, v20
    v_mul_f32 v21, s45, v21
    v_mul_f32 v22, s45, v22
    v_mul_f32 v23, s45, v23
    v_mul_f32 v24, s44, v24
    v_mul_f32 v25, s44, v25
    v_mul_f32 v26, s44, v26
    v_mul_f32 v27, s44, v27
    v_mul_f32 v28, s45, v28
    v_mul_f32 v29, s45, v29
    v_mul_f32 v30, s45, v30
    v_mul_f32 v31, s45, v31
    v_mul_f32 v32, s44, v32
    v_mul_f32 v33, s44, v33
    v_mul_f32 v34, s44, v34
    v_mul_f32 v35, s44, v35
    v_mul_f32 v36, s45, v36
    v_mul_f32 v37, s45, v37
    v_mul_f32 v38, s45, v38
    v_mul_f32 v39, s45, v39
    v_mul_f32 v40, s44, v40
    v_mul_f32 v41, s44, v41
    v_mul_f32 v42, s44, v42
    v_mul_f32 v43, s44, v43
    v_mul_f32 v44, s45, v44
    v_mul_f32 v45, s45, v45
    v_mul_f32 v46, s45, v46
    v_mul_f32 v47, s45, v47
    v_mul_f32 v48, s44, v48
    v_mul_f32 v49, s44, v49
    v_mul_f32 v50, s44, v50
    v_mul_f32 v51, s44, v51
    v_mul_f32 v52, s45, v52
    v_mul_f32 v53, s45, v53
    v_mul_f32 v54, s45, v54
    v_mul_f32 v55, s45, v55
    v_mul_f32 v56, s44, v56
    v_mul_f32 v57, s44, v57
    v_mul_f32 v58, s44, v58
    v_mul_f32 v59, s44, v59
    v_mul_f32 v60, s45, v60
    v_mul_f32 v61, s45, v61
    v_mul_f32 v62, s45, v62
    v_mul_f32 v63, s45, v63
    v_mul_f32 v64, s44, v64
    v_mul_f32 v65, s44, v65
    v_mul_f32 v66, s44, v66
    v_mul_f32 v67, s44, v67
    v_mul_f32 v68, s45, v68
    v_mul_f32 v69, s45, v69
    v_mul_f32 v70, s45, v70
    v_mul_f32 v71, s45, v71
    v_mul_f32 v72, s44, v72
    v_mul_f32 v73, s44, v73
    v_mul_f32 v74, s44, v74
    v_mul_f32 v75, s44, v75
    v_mul_f32 v76, s45, v76
    v_mul_f32 v77, s45, v77
    v_mul_f32 v78, s45, v78
    v_mul_f32 v79, s45, v79
    v_mul_f32 v80, s44, v80
    v_mul_f32 v81, s44, v81
    v_mul_f32 v82, s44, v82
    v_mul_f32 v83, s44, v83
    v_mul_f32 v84, s45, v84
    v_mul_f32 v85, s45, v85
    v_mul_f32 v86, s45, v86
    v_mul_f32 v87, s45, v87
    v_mul_f32 v88, s44, v88
    v_mul_f32 v89, s44, v89
    v_mul_f32 v90, s44, v90
    v_mul_f32 v91, s44, v91
    v_mul_f32 v92, s45, v92
    v_mul_f32 v93, s45, v93
    v_mul_f32 v94, s45, v94
    v_mul_f32 v95, s45, v95
    v_mul_f32 v96, s44, v96
    v_mul_f32 v97, s44, v97
    v_mul_f32 v98, s44, v98
    v_mul_f32 v99, s44, v99
    v_mul_f32 v100, s45, v100
    v_mul_f32 v101, s45, v101
    v_mul_f32 v102, s45, v102
    v_mul_f32 v103, s45, v103
    v_mul_f32 v104, s44, v104
    v_mul_f32 v105, s44, v105
    v_mul_f32 v106, s44, v106
    v_mul_f32 v107, s44, v107
    v_mul_f32 v108, s45, v108
    v_mul_f32 v109, s45, v109
    v_mul_f32 v110, s45, v110
    v_mul_f32 v111, s45, v111
    v_mul_f32 v112, s44, v112
    v_mul_f32 v113, s44, v113
    v_mul_f32 v114, s44, v114
    v_mul_f32 v115, s44, v115
    v_mul_f32 v116, s45, v116
    v_mul_f32 v117, s45, v117
    v_mul_f32 v118, s45, v118
    v_mul_f32 v119, s45, v119
    v_mul_f32 v120, s44, v120
    v_mul_f32 v121, s44, v121
    v_mul_f32 v122, s44, v122
    v_mul_f32 v123, s44, v123
    v_mul_f32 v124, s45, v124
    v_mul_f32 v125, s45, v125
    v_mul_f32 v126, s45, v126
    v_mul_f32 v127, s45, v127
    s_nop 7
    s_branch L_RB2
L_RS3:
    s_nop 7
    s_nop 7
    v_readlane_b32 s44, v255, 3
    v_readlane_b32 s45, v255, 11
    s_add_i32 s44, s44, 127
    s_lshl_b32 s44, s44, 23
    s_add_i32 s45, s45, 127
    s_lshl_b32 s45, s45, 23
    v_mul_f32 v0, s44, v0
    v_mul_f32 v1, s44, v1
    v_mul_f32 v2, s44, v2
    v_mul_f32 v3, s44, v3
    v_mul_f32 v4, s45, v4
    v_mul_f32 v5, s45, v5
    v_mul_f32 v6, s45, v6
    v_mul_f32 v7, s45, v7
    v_mul_f32 v8, s44, v8
    v_mul_f32 v9, s44, v9
    v_mul_f32 v10, s44, v10
    v_mul_f32 v11, s44, v11
    v_mul_f32 v12, s45, v12
    v_mul_f32 v13, s45, v13
    v_mul_f32 v14, s45, v14
    v_mul_f32 v15, s45, v15
    v_mul_f32 v16, s44, v16
    v_mul_f32 v17, s44, v17
    v_mul_f32 v18, s44, v18
    v_mul_f32 v19, s44, v19
    v_mul_f32 v20, s45, v20
    v_mul_f32 v21, s45, v21
    v_mul_f32 v22, s45, v22
    v_mul_f32 v23, s45, v23
    v_mul_f32 v24, s44, v24
    v_mul_f32 v25, s44, v25
    v_mul_f32 v26, s44, v26
    v_mul_f32 v27, s44, v27
    v_mul_f32 v28, s45, v28
    v_mul_f32 v29, s45, v29
    v_mul_f32 v30, s45, v30
    v_mul_f32 v31, s45, v31
    v_mul_f32 v32, s44, v32
    v_mul_f32 v33, s44, v33
    v_mul_f32 v34, s44, v34
    v_mul_f32 v35, s44, v35
    v_mul_f32 v36, s45, v36
    v_mul_f32 v37, s45, v37
    v_mul_f32 v38, s45, v38
    v_mul_f32 v39, s45, v39
    v_mul_f32 v40, s44, v40
    v_mul_f32 v41, s44, v41
    v_mul_f32 v42, s44, v42
    v_mul_f32 v43, s44, v43
    v_mul_f32 v44, s45, v44
    v_mul_f32 v45, s45, v45
    v_mul_f32 v46, s45, v46
    v_mul_f32 v47, s45, v47
    v_mul_f32 v48, s44, v48
    v_mul_f32 v49, s44, v49
    v_mul_f32 v50, s44, v50
    v_mul_f32 v51, s44, v51
    v_mul_f32 v52, s45, v52
    v_mul_f32 v53, s45, v53
    v_mul_f32 v54, s45, v54
    v_mul_f32 v55, s45, v55
    v_mul_f32 v56, s44, v56
    v_mul_f32 v57, s44, v57
    v_mul_f32 v58, s44, v58
    v_mul_f32 v59, s44, v59
    v_mul_f32 v60, s45, v60
    v_mul_f32 v61, s45, v61
    v_mul_f32 v62, s45, v62
    v_mul_f32 v63, s45, v63
    v_mul_f32 v64, s44, v64
    v_mul_f32 v65, s44, v65
    v_mul_f32 v66, s44, v66
    v_mul_f32 v67, s44, v67
    v_mul_f32 v68, s45, v68
    v_mul_f32 v69, s45, v69
    v_mul_f32 v70, s45, v70
    v_mul_f32 v71, s45, v71
    v_mul_f32 v72, s44, v72
    v_mul_f32 v73, s44, v73
    v_mul_f32 v74, s44, v74
    v_mul_f32 v75, s44, v75
    v_mul_f32 v76, s45, v76
    v_mul_f32 v77, s45, v77
    v_mul_f32 v78, s45, v78
    v_mul_f32 v79, s45, v79
    v_mul_f32 v80, s44, v80
    v_mul_f32 v81, s44, v81
    v_mul_f32 v82, s44, v82
    v_mul_f32 v83, s44, v83
    v_mul_f32 v84, s45, v84
    v_mul_f32 v85, s45, v85
    v_mul_f32 v86, s45, v86
    v_mul_f32 v87, s45, v87
    v_mul_f32 v88, s44, v88
    v_mul_f32 v89, s44, v89
    v_mul_f32 v90, s44, v90
    v_mul_f32 v91, s44, v91
    v_mul_f32 v92, s45, v92
    v_mul_f32 v93, s45, v93
    v_mul_f32 v94, s45, v94
    v_mul_f32 v95, s45, v95
    v_mul_f32 v96, s44, v96
    v_mul_f32 v97, s44, v97
    v_mul_f32 v98, s44, v98
    v_mul_f32 v99, s44, v99
    v_mul_f32 v100, s45, v100
    v_mul_f32 v101, s45, v101
    v_mul_f32 v102, s45, v102
    v_mul_f32 v103, s45, v103
    v_mul_f32 v104, s44, v104
    v_mul_f32 v105, s44, v105
    v_mul_f32 v106, s44, v106
    v_mul_f32 v107, s44, v107
    v_mul_f32 v108, s45, v108
    v_mul_f32 v109, s45, v109
    v_mul_f32 v110, s45, v110
    v_mul_f32 v111, s45, v111
    v_mul_f32 v112, s44, v112
    v_mul_f32 v113, s44, v113
    v_mul_f32 v114, s44, v114
    v_mul_f32 v115, s44, v115
    v_mul_f32 v116, s45, v116
    v_mul_f32 v117, s45, v117
    v_mul_f32 v118, s45, v118
    v_mul_f32 v119, s45, v119
    v_mul_f32 v120, s44, v120
    v_mul_f32 v121, s44, v121
    v_mul_f32 v122, s44, v122
    v_mul_f32 v123, s44, v123
    v_mul_f32 v124, s45, v124
    v_mul_f32 v125, s45, v125
    v_mul_f32 v126, s45, v126
    v_mul_f32 v127, s45, v127
    s_nop 7
    s_branch L_RB3
L_RS4:
    s_nop 7
    s_nop 7
    v_readlane_b32 s44, v255, 4
    v_readlane_b32 s45, v255, 12
    s_add_i32 s44, s44, 127
    s_lshl_b32 s44, s44, 23
    s_add_i32 s45, s45, 127
    s_lshl_b32 s45, s45, 23
    v_mul_f32 v0, s44, v0
    v_mul_f32 v1, s44, v1
    v_mul_f32 v2, s44, v2
    v_mul_f32 v3, s44, v3
    v_mul_f32 v4, s45, v4
    v_mul_f32 v5, s45, v5
    v_mul_f32 v6, s45, v6
    v_mul_f32 v7, s45, v7
    v_mul_f32 v8, s44, v8
    v_mul_f32 v9, s44, v9
    v_mul_f32 v10, s44, v10
    v_mul_f32 v11, s44, v11
    v_mul_f32 v12, s45, v12
    v_mul_f32 v13, s45, v13
    v_mul_f32 v14, s45, v14
    v_mul_f32 v15, s45, v15
    v_mul_f32 v16, s44, v16
    v_mul_f32 v17, s44, v17
    v_mul_f32 v18, s44, v18
    v_mul_f32 v19, s44, v19
    v_mul_f32 v20, s45, v20
    v_mul_f32 v21, s45, v21
    v_mul_f32 v22, s45, v22
    v_mul_f32 v23, s45, v23
    v_mul_f32 v24, s44, v24
    v_mul_f32 v25, s44, v25
    v_mul_f32 v26, s44, v26
    v_mul_f32 v27, s44, v27
    v_mul_f32 v28, s45, v28
    v_mul_f32 v29, s45, v29
    v_mul_f32 v30, s45, v30
    v_mul_f32 v31, s45, v31
    v_mul_f32 v32, s44, v32
    v_mul_f32 v33, s44, v33
    v_mul_f32 v34, s44, v34
    v_mul_f32 v35, s44, v35
    v_mul_f32 v36, s45, v36
    v_mul_f32 v37, s45, v37
    v_mul_f32 v38, s45, v38
    v_mul_f32 v39, s45, v39
    v_mul_f32 v40, s44, v40
    v_mul_f32 v41, s44, v41
    v_mul_f32 v42, s44, v42
    v_mul_f32 v43, s44, v43
    v_mul_f32 v44, s45, v44
    v_mul_f32 v45, s45, v45
    v_mul_f32 v46, s45, v46
    v_mul_f32 v47, s45, v47
    v_mul_f32 v48, s44, v48
    v_mul_f32 v49, s44, v49
    v_mul_f32 v50, s44, v50
    v_mul_f32 v51, s44, v51
    v_mul_f32 v52, s45, v52
    v_mul_f32 v53, s45, v53
    v_mul_f32 v54, s45, v54
    v_mul_f32 v55, s45, v55
    v_mul_f32 v56, s44, v56
    v_mul_f32 v57, s44, v57
    v_mul_f32 v58, s44, v58
    v_mul_f32 v59, s44, v59
    v_mul_f32 v60, s45, v60
    v_mul_f32 v61, s45, v61
    v_mul_f32 v62, s45, v62
    v_mul_f32 v63, s45, v63
    v_mul_f32 v64, s44, v64
    v_mul_f32 v65, s44, v65
    v_mul_f32 v66, s44, v66
    v_mul_f32 v67, s44, v67
    v_mul_f32 v68, s45, v68
    v_mul_f32 v69, s45, v69
    v_mul_f32 v70, s45, v70
    v_mul_f32 v71, s45, v71
    v_mul_f32 v72, s44, v72
    v_mul_f32 v73, s44, v73
    v_mul_f32 v74, s44, v74
    v_mul_f32 v75, s44, v75
    v_mul_f32 v76, s45, v76
    v_mul_f32 v77, s45, v77
    v_mul_f32 v78, s45, v78
    v_mul_f32 v79, s45, v79
    v_mul_f32 v80, s44, v80
    v_mul_f32 v81, s44, v81
    v_mul_f32 v82, s44, v82
    v_mul_f32 v83, s44, v83
    v_mul_f32 v84, s45, v84
    v_mul_f32 v85, s45, v85
    v_mul_f32 v86, s45, v86
    v_mul_f32 v87, s45, v87
    v_mul_f32 v88, s44, v88
    v_mul_f32 v89, s44, v89
    v_mul_f32 v90, s44, v90
    v_mul_f32 v91, s44, v91
    v_mul_f32 v92, s45, v92
    v_mul_f32 v93, s45, v93
    v_mul_f32 v94, s45, v94
    v_mul_f32 v95, s45, v95
    v_mul_f32 v96, s44, v96
    v_mul_f32 v97, s44, v97
    v_mul_f32 v98, s44, v98
    v_mul_f32 v99, s44, v99
    v_mul_f32 v100, s45, v100
    v_mul_f32 v101, s45, v101
    v_mul_f32 v102, s45, v102
    v_mul_f32 v103, s45, v103
    v_mul_f32 v104, s44, v104
    v_mul_f32 v105, s44, v105
    v_mul_f32 v106, s44, v106
    v_mul_f32 v107, s44, v107
    v_mul_f32 v108, s45, v108
    v_mul_f32 v109, s45, v109
    v_mul_f32 v110, s45, v110
    v_mul_f32 v111, s45, v111
    v_mul_f32 v112, s44, v112
    v_mul_f32 v113, s44, v113
    v_mul_f32 v114, s44, v114
    v_mul_f32 v115, s44, v115
    v_mul_f32 v116, s45, v116
    v_mul_f32 v117, s45, v117
    v_mul_f32 v118, s45, v118
    v_mul_f32 v119, s45, v119
    v_mul_f32 v120, s44, v120
    v_mul_f32 v121, s44, v121
    v_mul_f32 v122, s44, v122
    v_mul_f32 v123, s44, v123
    v_mul_f32 v124, s45, v124
    v_mul_f32 v125, s45, v125
    v_mul_f32 v126, s45, v126
    v_mul_f32 v127, s45, v127
    s_nop 7
    s_branch L_RB4
L_RS5:
    s_nop 7
    s_nop 7
    v_readlane_b32 s44, v255, 5
    v_readlane_b32 s45, v255, 13
    s_add_i32 s44, s44, 127
    s_lshl_b32 s44, s44, 23
    s_add_i32 s45, s45, 127
    s_lshl_b32 s45, s45, 23
    v_mul_f32 v0, s44, v0
    v_mul_f32 v1, s44, v1
    v_mul_f32 v2, s44, v2
    v_mul_f32 v3, s44, v3
    v_mul_f32 v4, s45, v4
    v_mul_f32 v5, s45, v5
    v_mul_f32 v6, s45, v6
    v_mul_f32 v7, s45, v7
    v_mul_f32 v8, s44, v8
    v_mul_f32 v9, s44, v9
    v_mul_f32 v10, s44, v10
    v_mul_f32 v11, s44, v11
    v_mul_f32 v12, s45, v12
    v_mul_f32 v13, s45, v13
    v_mul_f32 v14, s45, v14
    v_mul_f32 v15, s45, v15
    v_mul_f32 v16, s44, v16
    v_mul_f32 v17, s44, v17
    v_mul_f32 v18, s44, v18
    v_mul_f32 v19, s44, v19
    v_mul_f32 v20, s45, v20
    v_mul_f32 v21, s45, v21
    v_mul_f32 v22, s45, v22
    v_mul_f32 v23, s45, v23
    v_mul_f32 v24, s44, v24
    v_mul_f32 v25, s44, v25
    v_mul_f32 v26, s44, v26
    v_mul_f32 v27, s44, v27
    v_mul_f32 v28, s45, v28
    v_mul_f32 v29, s45, v29
    v_mul_f32 v30, s45, v30
    v_mul_f32 v31, s45, v31
    v_mul_f32 v32, s44, v32
    v_mul_f32 v33, s44, v33
    v_mul_f32 v34, s44, v34
    v_mul_f32 v35, s44, v35
    v_mul_f32 v36, s45, v36
    v_mul_f32 v37, s45, v37
    v_mul_f32 v38, s45, v38
    v_mul_f32 v39, s45, v39
    v_mul_f32 v40, s44, v40
    v_mul_f32 v41, s44, v41
    v_mul_f32 v42, s44, v42
    v_mul_f32 v43, s44, v43
    v_mul_f32 v44, s45, v44
    v_mul_f32 v45, s45, v45
    v_mul_f32 v46, s45, v46
    v_mul_f32 v47, s45, v47
    v_mul_f32 v48, s44, v48
    v_mul_f32 v49, s44, v49
    v_mul_f32 v50, s44, v50
    v_mul_f32 v51, s44, v51
    v_mul_f32 v52, s45, v52
    v_mul_f32 v53, s45, v53
    v_mul_f32 v54, s45, v54
    v_mul_f32 v55, s45, v55
    v_mul_f32 v56, s44, v56
    v_mul_f32 v57, s44, v57
    v_mul_f32 v58, s44, v58
    v_mul_f32 v59, s44, v59
    v_mul_f32 v60, s45, v60
    v_mul_f32 v61, s45, v61
    v_mul_f32 v62, s45, v62
    v_mul_f32 v63, s45, v63
    v_mul_f32 v64, s44, v64
    v_mul_f32 v65, s44, v65
    v_mul_f32 v66, s44, v66
    v_mul_f32 v67, s44, v67
    v_mul_f32 v68, s45, v68
    v_mul_f32 v69, s45, v69
    v_mul_f32 v70, s45, v70
    v_mul_f32 v71, s45, v71
    v_mul_f32 v72, s44, v72
    v_mul_f32 v73, s44, v73
    v_mul_f32 v74, s44, v74
    v_mul_f32 v75, s44, v75
    v_mul_f32 v76, s45, v76
    v_mul_f32 v77, s45, v77
    v_mul_f32 v78, s45, v78
    v_mul_f32 v79, s45, v79
    v_mul_f32 v80, s44, v80
    v_mul_f32 v81, s44, v81
    v_mul_f32 v82, s44, v82
    v_mul_f32 v83, s44, v83
    v_mul_f32 v84, s45, v84
    v_mul_f32 v85, s45, v85
    v_mul_f32 v86, s45, v86
    v_mul_f32 v87, s45, v87
    v_mul_f32 v88, s44, v88
    v_mul_f32 v89, s44, v89
    v_mul_f32 v90, s44, v90
    v_mul_f32 v91, s44, v91
    v_mul_f32 v92, s45, v92
    v_mul_f32 v93, s45, v93
    v_mul_f32 v94, s45, v94
    v_mul_f32 v95, s45, v95
    v_mul_f32 v96, s44, v96
    v_mul_f32 v97, s44, v97
    v_mul_f32 v98, s44, v98
    v_mul_f32 v99, s44, v99
    v_mul_f32 v100, s45, v100
    v_mul_f32 v101, s45, v101
    v_mul_f32 v102, s45, v102
    v_mul_f32 v103, s45, v103
    v_mul_f32 v104, s44, v104
    v_mul_f32 v105, s44, v105
    v_mul_f32 v106, s44, v106
    v_mul_f32 v107, s44, v107
    v_mul_f32 v108, s45, v108
    v_mul_f32 v109, s45, v109
    v_mul_f32 v110, s45, v110
    v_mul_f32 v111, s45, v111
    v_mul_f32 v112, s44, v112
    v_mul_f32 v113, s44, v113
    v_mul_f32 v114, s44, v114
    v_mul_f32 v115, s44, v115
    v_mul_f32 v116, s45, v116
    v_mul_f32 v117, s45, v117
    v_mul_f32 v118, s45, v118
    v_mul_f32 v119, s45, v119
    v_mul_f32 v120, s44, v120
    v_mul_f32 v121, s44, v121
    v_mul_f32 v122, s44, v122
    v_mul_f32 v123, s44, v123
    v_mul_f32 v124, s45, v124
    v_mul_f32 v125, s45, v125
    v_mul_f32 v126, s45, v126
    v_mul_f32 v127, s45, v127
    s_nop 7
    s_branch L_RB5
L_RS6:
    s_nop 7
    s_nop 7
    v_readlane_b32 s44, v255, 6
    v_readlane_b32 s45, v255, 14
    s_add_i32 s44, s44, 127
    s_lshl_b32 s44, s44, 23
    s_add_i32 s45, s45, 127
    s_lshl_b32 s45, s45, 23
    v_mul_f32 v0, s44, v0
    v_mul_f32 v1, s44, v1
    v_mul_f32 v2, s44, v2
    v_mul_f32 v3, s44, v3
    v_mul_f32 v4, s45, v4
    v_mul_f32 v5, s45, v5
    v_mul_f32 v6, s45, v6
    v_mul_f32 v7, s45, v7
    v_mul_f32 v8, s44, v8
    v_mul_f32 v9, s44, v9
    v_mul_f32 v10, s44, v10
    v_mul_f32 v11, s44, v11
    v_mul_f32 v12, s45, v12
    v_mul_f32 v13, s45, v13
    v_mul_f32 v14, s45, v14
    v_mul_f32 v15, s45, v15
    v_mul_f32 v16, s44, v16
    v_mul_f32 v17, s44, v17
    v_mul_f32 v18, s44, v18
    v_mul_f32 v19, s44, v19
    v_mul_f32 v20, s45, v20
    v_mul_f32 v21, s45, v21
    v_mul_f32 v22, s45, v22
    v_mul_f32 v23, s45, v23
    v_mul_f32 v24, s44, v24
    v_mul_f32 v25, s44, v25
    v_mul_f32 v26, s44, v26
    v_mul_f32 v27, s44, v27
    v_mul_f32 v28, s45, v28
    v_mul_f32 v29, s45, v29
    v_mul_f32 v30, s45, v30
    v_mul_f32 v31, s45, v31
    v_mul_f32 v32, s44, v32
    v_mul_f32 v33, s44, v33
    v_mul_f32 v34, s44, v34
    v_mul_f32 v35, s44, v35
    v_mul_f32 v36, s45, v36
    v_mul_f32 v37, s45, v37
    v_mul_f32 v38, s45, v38
    v_mul_f32 v39, s45, v39
    v_mul_f32 v40, s44, v40
    v_mul_f32 v41, s44, v41
    v_mul_f32 v42, s44, v42
    v_mul_f32 v43, s44, v43
    v_mul_f32 v44, s45, v44
    v_mul_f32 v45, s45, v45
    v_mul_f32 v46, s45, v46
    v_mul_f32 v47, s45, v47
    v_mul_f32 v48, s44, v48
    v_mul_f32 v49, s44, v49
    v_mul_f32 v50, s44, v50
    v_mul_f32 v51, s44, v51
    v_mul_f32 v52, s45, v52
    v_mul_f32 v53, s45, v53
    v_mul_f32 v54, s45, v54
    v_mul_f32 v55, s45, v55
    v_mul_f32 v56, s44, v56
    v_mul_f32 v57, s44, v57
    v_mul_f32 v58, s44, v58
    v_mul_f32 v59, s44, v59
    v_mul_f32 v60, s45, v60
    v_mul_f32 v61, s45, v61
    v_mul_f32 v62, s45, v62
    v_mul_f32 v63, s45, v63
    v_mul_f32 v64, s44, v64
    v_mul_f32 v65, s44, v65
    v_mul_f32 v66, s44, v66
    v_mul_f32 v67, s44, v67
    v_mul_f32 v68, s45, v68
    v_mul_f32 v69, s45, v69
    v_mul_f32 v70, s45, v70
    v_mul_f32 v71, s45, v71
    v_mul_f32 v72, s44, v72
    v_mul_f32 v73, s44, v73
    v_mul_f32 v74, s44, v74
    v_mul_f32 v75, s44, v75
    v_mul_f32 v76, s45, v76
    v_mul_f32 v77, s45, v77
    v_mul_f32 v78, s45, v78
    v_mul_f32 v79, s45, v79
    v_mul_f32 v80, s44, v80
    v_mul_f32 v81, s44, v81
    v_mul_f32 v82, s44, v82
    v_mul_f32 v83, s44, v83
    v_mul_f32 v84, s45, v84
    v_mul_f32 v85, s45, v85
    v_mul_f32 v86, s45, v86
    v_mul_f32 v87, s45, v87
    v_mul_f32 v88, s44, v88
    v_mul_f32 v89, s44, v89
    v_mul_f32 v90, s44, v90
    v_mul_f32 v91, s44, v91
    v_mul_f32 v92, s45, v92
    v_mul_f32 v93, s45, v93
    v_mul_f32 v94, s45, v94
    v_mul_f32 v95, s45, v95
    v_mul_f32 v96, s44, v96
    v_mul_f32 v97, s44, v97
    v_mul_f32 v98, s44, v98
    v_mul_f32 v99, s44, v99
    v_mul_f32 v100, s45, v100
    v_mul_f32 v101, s45, v101
    v_mul_f32 v102, s45, v102
    v_mul_f32 v103, s45, v103
    v_mul_f32 v104, s44, v104
    v_mul_f32 v105, s44, v105
    v_mul_f32 v106, s44, v106
    v_mul_f32 v107, s44, v107
    v_mul_f32 v108, s45, v108
    v_mul_f32 v109, s45, v109
    v_mul_f32 v110, s45, v110
    v_mul_f32 v111, s45, v111
    v_mul_f32 v112, s44, v112
    v_mul_f32 v113, s44, v113
    v_mul_f32 v114, s44, v114
    v_mul_f32 v115, s44, v115
    v_mul_f32 v116, s45, v116
    v_mul_f32 v117, s45, v117
    v_mul_f32 v118, s45, v118
    v_mul_f32 v119, s45, v119
    v_mul_f32 v120, s44, v120
    v_mul_f32 v121, s44, v121
    v_mul_f32 v122, s44, v122
    v_mul_f32 v123, s44, v123
    v_mul_f32 v124, s45, v124
    v_mul_f32 v125, s45, v125
    v_mul_f32 v126, s45, v126
    v_mul_f32 v127, s45, v127
    s_nop 7
    s_branch L_RB6
L_RS7:
    s_nop 7
    s_nop 7
    v_readlane_b32 s44, v255, 7
    v_readlane_b32 s45, v255, 15
    s_add_i32 s44, s44, 127
    s_lshl_b32 s44, s44, 23
    s_add_i32 s45, s45, 127
    s_lshl_b32 s45, s45, 23
    v_mul_f32 v0, s44, v0
    v_mul_f32 v1, s44, v1
    v_mul_f32 v2, s44, v2
    v_mul_f32 v3, s44, v3
    v_mul_f32 v4, s45, v4
    v_mul_f32 v5, s45, v5
    v_mul_f32 v6, s45, v6
    v_mul_f32 v7, s45, v7
    v_mul_f32 v8, s44, v8
    v_mul_f32 v9, s44, v9
    v_mul_f32 v10, s44, v10
    v_mul_f32 v11, s44, v11
    v_mul_f32 v12, s45, v12
    v_mul_f32 v13, s45, v13
    v_mul_f32 v14, s45, v14
    v_mul_f32 v15, s45, v15
    v_mul_f32 v16, s44, v16
    v_mul_f32 v17, s44, v17
    v_mul_f32 v18, s44, v18
    v_mul_f32 v19, s44, v19
    v_mul_f32 v20, s45, v20
    v_mul_f32 v21, s45, v21
    v_mul_f32 v22, s45, v22
    v_mul_f32 v23, s45, v23
    v_mul_f32 v24, s44, v24
    v_mul_f32 v25, s44, v25
    v_mul_f32 v26, s44, v26
    v_mul_f32 v27, s44, v27
    v_mul_f32 v28, s45, v28
    v_mul_f32 v29, s45, v29
    v_mul_f32 v30, s45, v30
    v_mul_f32 v31, s45, v31
    v_mul_f32 v32, s44, v32
    v_mul_f32 v33, s44, v33
    v_mul_f32 v34, s44, v34
    v_mul_f32 v35, s44, v35
    v_mul_f32 v36, s45, v36
    v_mul_f32 v37, s45, v37
    v_mul_f32 v38, s45, v38
    v_mul_f32 v39, s45, v39
    v_mul_f32 v40, s44, v40
    v_mul_f32 v41, s44, v41
    v_mul_f32 v42, s44, v42
    v_mul_f32 v43, s44, v43
    v_mul_f32 v44, s45, v44
    v_mul_f32 v45, s45, v45
    v_mul_f32 v46, s45, v46
    v_mul_f32 v47, s45, v47
    v_mul_f32 v48, s44, v48
    v_mul_f32 v49, s44, v49
    v_mul_f32 v50, s44, v50
    v_mul_f32 v51, s44, v51
    v_mul_f32 v52, s45, v52
    v_mul_f32 v53, s45, v53
    v_mul_f32 v54, s45, v54
    v_mul_f32 v55, s45, v55
    v_mul_f32 v56, s44, v56
    v_mul_f32 v57, s44, v57
    v_mul_f32 v58, s44, v58
    v_mul_f32 v59, s44, v59
    v_mul_f32 v60, s45, v60
    v_mul_f32 v61, s45, v61
    v_mul_f32 v62, s45, v62
    v_mul_f32 v63, s45, v63
    v_mul_f32 v64, s44, v64
    v_mul_f32 v65, s44, v65
    v_mul_f32 v66, s44, v66
    v_mul_f32 v67, s44, v67
    v_mul_f32 v68, s45, v68
    v_mul_f32 v69, s45, v69
    v_mul_f32 v70, s45, v70
    v_mul_f32 v71, s45, v71
    v_mul_f32 v72, s44, v72
    v_mul_f32 v73, s44, v73
    v_mul_f32 v74, s44, v74
    v_mul_f32 v75, s44, v75
    v_mul_f32 v76, s45, v76
    v_mul_f32 v77, s45, v77
    v_mul_f32 v78, s45, v78
    v_mul_f32 v79, s45, v79
    v_mul_f32 v80, s44, v80
    v_mul_f32 v81, s44, v81
    v_mul_f32 v82, s44, v82
    v_mul_f32 v83, s44, v83
    v_mul_f32 v84, s45, v84
    v_mul_f32 v85, s45, v85
    v_mul_f32 v86, s45, v86
    v_mul_f32 v87, s45, v87
    v_mul_f32 v88, s44, v88
    v_mul_f32 v89, s44, v89
    v_mul_f32 v90, s44, v90
    v_mul_f32 v91, s44, v91
    v_mul_f32 v92, s45, v92
    v_mul_f32 v93, s45, v93
    v_mul_f32 v94, s45, v94
    v_mul_f32 v95, s45, v95
    v_mul_f32 v96, s44, v96
    v_mul_f32 v97, s44, v97
    v_mul_f32 v98, s44, v98
    v_mul_f32 v99, s44, v99
    v_mul_f32 v100, s45, v100
    v_mul_f32 v101, s45, v101
    v_mul_f32 v102, s45, v102
    v_mul_f32 v103, s45, v103
    v_mul_f32 v104, s44, v104
    v_mul_f32 v105, s44, v105
    v_mul_f32 v106, s44, v106
    v_mul_f32 v107, s44, v107
    v_mul_f32 v108, s45, v108
    v_mul_f32 v109, s45, v109
    v_mul_f32 v110, s45, v110
    v_mul_f32 v111, s45, v111
    v_mul_f32 v112, s44, v112
    v_mul_f32 v113, s44, v113
    v_mul_f32 v114, s44, v114
    v_mul_f32 v115, s44, v115
    v_mul_f32 v116, s45, v116
    v_mul_f32 v117, s45, v117
    v_mul_f32 v118, s45, v118
    v_mul_f32 v119, s45, v119
    v_mul_f32 v120, s44, v120
    v_mul_f32 v121, s44, v121
    v_mul_f32 v122, s44, v122
    v_mul_f32 v123, s44, v123
    v_mul_f32 v124, s45, v124
    v_mul_f32 v125, s45, v125
    v_mul_f32 v126, s45, v126
    v_mul_f32 v127, s45, v127
    s_nop 7
    s_branch L_RB7
L_RS8:
    s_nop 7
    s_nop 7
    v_readlane_b32 s44, v255, 0
    v_readlane_b32 s45, v255, 8
    s_add_i32 s44, s44, 127
    s_lshl_b32 s44, s44, 23
    s_add_i32 s45, s45, 127
    s_lshl_b32 s45, s45, 23
    v_mul_f32 v0, s44, v0
    v_mul_f32 v1, s44, v1
    v_mul_f32 v2, s44, v2
    v_mul_f32 v3, s44, v3
    v_mul_f32 v4, s45, v4
    v_mul_f32 v5, s45, v5
    v_mul_f32 v6, s45, v6
    v_mul_f32 v7, s45, v7
    v_mul_f32 v8, s44, v8
    v_mul_f32 v9, s44, v9
    v_mul_f32 v10, s44, v10
    v_mul_f32 v11, s44, v11
    v_mul_f32 v12, s45, v12
    v_mul_f32 v13, s45, v13
    v_mul_f32 v14, s45, v14
    v_mul_f32 v15, s45, v15
    v_mul_f32 v16, s44, v16
    v_mul_f32 v17, s44, v17
    v_mul_f32 v18, s44, v18
    v_mul_f32 v19, s44, v19
    v_mul_f32 v20, s45, v20
    v_mul_f32 v21, s45, v21
    v_mul_f32 v22, s45, v22
    v_mul_f32 v23, s45, v23
    v_mul_f32 v24, s44, v24
    v_mul_f32 v25, s44, v25
    v_mul_f32 v26, s44, v26
    v_mul_f32 v27, s44, v27
    v_mul_f32 v28, s45, v28
    v_mul_f32 v29, s45, v29
    v_mul_f32 v30, s45, v30
    v_mul_f32 v31, s45, v31
    v_mul_f32 v32, s44, v32
    v_mul_f32 v33, s44, v33
    v_mul_f32 v34, s44, v34
    v_mul_f32 v35, s44, v35
    v_mul_f32 v36, s45, v36
    v_mul_f32 v37, s45, v37
    v_mul_f32 v38, s45, v38
    v_mul_f32 v39, s45, v39
    v_mul_f32 v40, s44, v40
    v_mul_f32 v41, s44, v41
    v_mul_f32 v42, s44, v42
    v_mul_f32 v43, s44, v43
    v_mul_f32 v44, s45, v44
    v_mul_f32 v45, s45, v45
    v_mul_f32 v46, s45, v46
    v_mul_f32 v47, s45, v47
    v_mul_f32 v48, s44, v48
    v_mul_f32 v49, s44, v49
    v_mul_f32 v50, s44, v50
    v_mul_f32 v51, s44, v51
    v_mul_f32 v52, s45, v52
    v_mul_f32 v53, s45, v53
    v_mul_f32 v54, s45, v54
    v_mul_f32 v55, s45, v55
    v_mul_f32 v56, s44, v56
    v_mul_f32 v57, s44, v57
    v_mul_f32 v58, s44, v58
    v_mul_f32 v59, s44, v59
    v_mul_f32 v60, s45, v60
    v_mul_f32 v61, s45, v61
    v_mul_f32 v62, s45, v62
    v_mul_f32 v63, s45, v63
    v_mul_f32 v64, s44, v64
    v_mul_f32 v65, s44, v65
    v_mul_f32 v66, s44, v66
    v_mul_f32 v67, s44, v67
    v_mul_f32 v68, s45, v68
    v_mul_f32 v69, s45, v69
    v_mul_f32 v70, s45, v70
    v_mul_f32 v71, s45, v71
    v_mul_f32 v72, s44, v72
    v_mul_f32 v73, s44, v73
    v_mul_f32 v74, s44, v74
    v_mul_f32 v75, s44, v75
    v_mul_f32 v76, s45, v76
    v_mul_f32 v77, s45, v77
    v_mul_f32 v78, s45, v78
    v_mul_f32 v79, s45, v79
    v_mul_f32 v80, s44, v80
    v_mul_f32 v81, s44, v81
    v_mul_f32 v82, s44, v82
    v_mul_f32 v83, s44, v83
    v_mul_f32 v84, s45, v84
    v_mul_f32 v85, s45, v85
    v_mul_f32 v86, s45, v86
    v_mul_f32 v87, s45, v87
    v_mul_f32 v88, s44, v88
    v_mul_f32 v89, s44, v89
    v_mul_f32 v90, s44, v90
    v_mul_f32 v91, s44, v91
    v_mul_f32 v92, s45, v92
    v_mul_f32 v93, s45, v93
    v_mul_f32 v94, s45, v94
    v_mul_f32 v95, s45, v95
    v_mul_f32 v96, s44, v96
    v_mul_f32 v97, s44, v97
    v_mul_f32 v98, s44, v98
    v_mul_f32 v99, s44, v99
    v_mul_f32 v100, s45, v100
    v_mul_f32 v101, s45, v101
    v_mul_f32 v102, s45, v102
    v_mul_f32 v103, s45, v103
    v_mul_f32 v104, s44, v104
    v_mul_f32 v105, s44, v105
    v_mul_f32 v106, s44, v106
    v_mul_f32 v107, s44, v107
    v_mul_f32 v108, s45, v108
    v_mul_f32 v109, s45, v109
    v_mul_f32 v110, s45, v110
    v_mul_f32 v111, s45, v111
    v_mul_f32 v112, s44, v112
    v_mul_f32 v113, s44, v113
    v_mul_f32 v114, s44, v114
    v_mul_f32 v115, s44, v115
    v_mul_f32 v116, s45, v116
    v_mul_f32 v117, s45, v117
    v_mul_f32 v118, s45, v118
    v_mul_f32 v119, s45, v119
    v_mul_f32 v120, s44, v120
    v_mul_f32 v121, s44, v121
    v_mul_f32 v122, s44, v122
    v_mul_f32 v123, s44, v123
    v_mul_f32 v124, s45, v124
    v_mul_f32 v125, s45, v125
    v_mul_f32 v126, s45, v126
    v_mul_f32 v127, s45, v127
    s_nop 7
    s_branch L_RB8
L_RS9:
    s_nop 7
    s_nop 7
    v_readlane_b32 s44, v255, 1
    v_readlane_b32 s45, v255, 9
    s_add_i32 s44, s44, 127
    s_lshl_b32 s44, s44, 23
    s_add_i32 s45, s45, 127
    s_lshl_b32 s45, s45, 23
    v_mul_f32 v0, s44, v0
    v_mul_f32 v1, s44, v1
    v_mul_f32 v2, s44, v2
    v_mul_f32 v3, s44, v3
    v_mul_f32 v4, s45, v4
    v_mul_f32 v5, s45, v5
    v_mul_f32 v6, s45, v6
    v_mul_f32 v7, s45, v7
    v_mul_f32 v8, s44, v8
    v_mul_f32 v9, s44, v9
    v_mul_f32 v10, s44, v10
    v_mul_f32 v11, s44, v11
    v_mul_f32 v12, s45, v12
    v_mul_f32 v13, s45, v13
    v_mul_f32 v14, s45, v14
    v_mul_f32 v15, s45, v15
    v_mul_f32 v16, s44, v16
    v_mul_f32 v17, s44, v17
    v_mul_f32 v18, s44, v18
    v_mul_f32 v19, s44, v19
    v_mul_f32 v20, s45, v20
    v_mul_f32 v21, s45, v21
    v_mul_f32 v22, s45, v22
    v_mul_f32 v23, s45, v23
    v_mul_f32 v24, s44, v24
    v_mul_f32 v25, s44, v25
    v_mul_f32 v26, s44, v26
    v_mul_f32 v27, s44, v27
    v_mul_f32 v28, s45, v28
    v_mul_f32 v29, s45, v29
    v_mul_f32 v30, s45, v30
    v_mul_f32 v31, s45, v31
    v_mul_f32 v32, s44, v32
    v_mul_f32 v33, s44, v33
    v_mul_f32 v34, s44, v34
    v_mul_f32 v35, s44, v35
    v_mul_f32 v36, s45, v36
    v_mul_f32 v37, s45, v37
    v_mul_f32 v38, s45, v38
    v_mul_f32 v39, s45, v39
    v_mul_f32 v40, s44, v40
    v_mul_f32 v41, s44, v41
    v_mul_f32 v42, s44, v42
    v_mul_f32 v43, s44, v43
    v_mul_f32 v44, s45, v44
    v_mul_f32 v45, s45, v45
    v_mul_f32 v46, s45, v46
    v_mul_f32 v47, s45, v47
    v_mul_f32 v48, s44, v48
    v_mul_f32 v49, s44, v49
    v_mul_f32 v50, s44, v50
    v_mul_f32 v51, s44, v51
    v_mul_f32 v52, s45, v52
    v_mul_f32 v53, s45, v53
    v_mul_f32 v54, s45, v54
    v_mul_f32 v55, s45, v55
    v_mul_f32 v56, s44, v56
    v_mul_f32 v57, s44, v57
    v_mul_f32 v58, s44, v58
    v_mul_f32 v59, s44, v59
    v_mul_f32 v60, s45, v60
    v_mul_f32 v61, s45, v61
    v_mul_f32 v62, s45, v62
    v_mul_f32 v63, s45, v63
    v_mul_f32 v64, s44, v64
    v_mul_f32 v65, s44, v65
    v_mul_f32 v66, s44, v66
    v_mul_f32 v67, s44, v67
    v_mul_f32 v68, s45, v68
    v_mul_f32 v69, s45, v69
    v_mul_f32 v70, s45, v70
    v_mul_f32 v71, s45, v71
    v_mul_f32 v72, s44, v72
    v_mul_f32 v73, s44, v73
    v_mul_f32 v74, s44, v74
    v_mul_f32 v75, s44, v75
    v_mul_f32 v76, s45, v76
    v_mul_f32 v77, s45, v77
    v_mul_f32 v78, s45, v78
    v_mul_f32 v79, s45, v79
    v_mul_f32 v80, s44, v80
    v_mul_f32 v81, s44, v81
    v_mul_f32 v82, s44, v82
    v_mul_f32 v83, s44, v83
    v_mul_f32 v84, s45, v84
    v_mul_f32 v85, s45, v85
    v_mul_f32 v86, s45, v86
    v_mul_f32 v87, s45, v87
    v_mul_f32 v88, s44, v88
    v_mul_f32 v89, s44, v89
    v_mul_f32 v90, s44, v90
    v_mul_f32 v91, s44, v91
    v_mul_f32 v92, s45, v92
    v_mul_f32 v93, s45, v93
    v_mul_f32 v94, s45, v94
    v_mul_f32 v95, s45, v95
    v_mul_f32 v96, s44, v96
    v_mul_f32 v97, s44, v97
    v_mul_f32 v98, s44, v98
    v_mul_f32 v99, s44, v99
    v_mul_f32 v100, s45, v100
    v_mul_f32 v101, s45, v101
    v_mul_f32 v102, s45, v102
    v_mul_f32 v103, s45, v103
    v_mul_f32 v104, s44, v104
    v_mul_f32 v105, s44, v105
    v_mul_f32 v106, s44, v106
    v_mul_f32 v107, s44, v107
    v_mul_f32 v108, s45, v108
    v_mul_f32 v109, s45, v109
    v_mul_f32 v110, s45, v110
    v_mul_f32 v111, s45, v111
    v_mul_f32 v112, s44, v112
    v_mul_f32 v113, s44, v113
    v_mul_f32 v114, s44, v114
    v_mul_f32 v115, s44, v115
    v_mul_f32 v116, s45, v116
    v_mul_f32 v117, s45, v117
    v_mul_f32 v118, s45, v118
    v_mul_f32 v119, s45, v119
    v_mul_f32 v120, s44, v120
    v_mul_f32 v121, s44, v121
    v_mul_f32 v122, s44, v122
    v_mul_f32 v123, s44, v123
    v_mul_f32 v124, s45, v124
    v_mul_f32 v125, s45, v125
    v_mul_f32 v126, s45, v126
    v_mul_f32 v127, s45, v127
    s_nop 7
    s_branch L_RB9
L_RS10:
    s_nop 7
    s_nop 7
    v_readlane_b32 s44, v255, 2
    v_readlane_b32 s45, v255, 10
    s_add_i32 s44, s44, 127
    s_lshl_b32 s44, s44, 23
    s_add_i32 s45, s45, 127
    s_lshl_b32 s45, s45, 23
    v_mul_f32 v0, s44, v0
    v_mul_f32 v1, s44, v1
    v_mul_f32 v2, s44, v2
    v_mul_f32 v3, s44, v3
    v_mul_f32 v4, s45, v4
    v_mul_f32 v5, s45, v5
    v_mul_f32 v6, s45, v6
    v_mul_f32 v7, s45, v7
    v_mul_f32 v8, s44, v8
    v_mul_f32 v9, s44, v9
    v_mul_f32 v10, s44, v10
    v_mul_f32 v11, s44, v11
    v_mul_f32 v12, s45, v12
    v_mul_f32 v13, s45, v13
    v_mul_f32 v14, s45, v14
    v_mul_f32 v15, s45, v15
    v_mul_f32 v16, s44, v16
    v_mul_f32 v17, s44, v17
    v_mul_f32 v18, s44, v18
    v_mul_f32 v19, s44, v19
    v_mul_f32 v20, s45, v20
    v_mul_f32 v21, s45, v21
    v_mul_f32 v22, s45, v22
    v_mul_f32 v23, s45, v23
    v_mul_f32 v24, s44, v24
    v_mul_f32 v25, s44, v25
    v_mul_f32 v26, s44, v26
    v_mul_f32 v27, s44, v27
    v_mul_f32 v28, s45, v28
    v_mul_f32 v29, s45, v29
    v_mul_f32 v30, s45, v30
    v_mul_f32 v31, s45, v31
    v_mul_f32 v32, s44, v32
    v_mul_f32 v33, s44, v33
    v_mul_f32 v34, s44, v34
    v_mul_f32 v35, s44, v35
    v_mul_f32 v36, s45, v36
    v_mul_f32 v37, s45, v37
    v_mul_f32 v38, s45, v38
    v_mul_f32 v39, s45, v39
    v_mul_f32 v40, s44, v40
    v_mul_f32 v41, s44, v41
    v_mul_f32 v42, s44, v42
    v_mul_f32 v43, s44, v43
    v_mul_f32 v44, s45, v44
    v_mul_f32 v45, s45, v45
    v_mul_f32 v46, s45, v46
    v_mul_f32 v47, s45, v47
    v_mul_f32 v48, s44, v48
    v_mul_f32 v49, s44, v49
    v_mul_f32 v50, s44, v50
    v_mul_f32 v51, s44, v51
    v_mul_f32 v52, s45, v52
    v_mul_f32 v53, s45, v53
    v_mul_f32 v54, s45, v54
    v_mul_f32 v55, s45, v55
    v_mul_f32 v56, s44, v56
    v_mul_f32 v57, s44, v57
    v_mul_f32 v58, s44, v58
    v_mul_f32 v59, s44, v59
    v_mul_f32 v60, s45, v60
    v_mul_f32 v61, s45, v61
    v_mul_f32 v62, s45, v62
    v_mul_f32 v63, s45, v63
    v_mul_f32 v64, s44, v64
    v_mul_f32 v65, s44, v65
    v_mul_f32 v66, s44, v66
    v_mul_f32 v67, s44, v67
    v_mul_f32 v68, s45, v68
    v_mul_f32 v69, s45, v69
    v_mul_f32 v70, s45, v70
    v_mul_f32 v71, s45, v71
    v_mul_f32 v72, s44, v72
    v_mul_f32 v73, s44, v73
    v_mul_f32 v74, s44, v74
    v_mul_f32 v75, s44, v75
    v_mul_f32 v76, s45, v76
    v_mul_f32 v77, s45, v77
    v_mul_f32 v78, s45, v78
    v_mul_f32 v79, s45, v79
    v_mul_f32 v80, s44, v80
    v_mul_f32 v81, s44, v81
    v_mul_f32 v82, s44, v82
    v_mul_f32 v83, s44, v83
    v_mul_f32 v84, s45, v84
    v_mul_f32 v85, s45, v85
    v_mul_f32 v86, s45, v86
    v_mul_f32 v87, s45, v87
    v_mul_f32 v88, s44, v88
    v_mul_f32 v89, s44, v89
    v_mul_f32 v90, s44, v90
    v_mul_f32 v91, s44, v91
    v_mul_f32 v92, s45, v92
    v_mul_f32 v93, s45, v93
    v_mul_f32 v94, s45, v94
    v_mul_f32 v95, s45, v95
    v_mul_f32 v96, s44, v96
    v_mul_f32 v97, s44, v97
    v_mul_f32 v98, s44, v98
    v_mul_f32 v99, s44, v99
    v_mul_f32 v100, s45, v100
    v_mul_f32 v101, s45, v101
    v_mul_f32 v102, s45, v102
    v_mul_f32 v103, s45, v103
    v_mul_f32 v104, s44, v104
    v_mul_f32 v105, s44, v105
    v_mul_f32 v106, s44, v106
    v_mul_f32 v107, s44, v107
    v_mul_f32 v108, s45, v108
    v_mul_f32 v109, s45, v109
    v_mul_f32 v110, s45, v110
    v_mul_f32 v111, s45, v111
    v_mul_f32 v112, s44, v112
    v_mul_f32 v113, s44, v113
    v_mul_f32 v114, s44, v114
    v_mul_f32 v115, s44, v115
    v_mul_f32 v116, s45, v116
    v_mul_f32 v117, s45, v117
    v_mul_f32 v118, s45, v118
    v_mul_f32 v119, s45, v119
    v_mul_f32 v120, s44, v120
    v_mul_f32 v121, s44, v121
    v_mul_f32 v122, s44, v122
    v_mul_f32 v123, s44, v123
    v_mul_f32 v124, s45, v124
    v_mul_f32 v125, s45, v125
    v_mul_f32 v126, s45, v126
    v_mul_f32 v127, s45, v127
    s_nop 7
    s_branch L_RB10
L_RS11:
    s_nop 7
    s_nop 7
    v_readlane_b32 s44, v255, 3
    v_readlane_b32 s45, v255, 11
    s_add_i32 s44, s44, 127
    s_lshl_b32 s44, s44, 23
    s_add_i32 s45, s45, 127
    s_lshl_b32 s45, s45, 23
    v_mul_f32 v0, s44, v0
    v_mul_f32 v1, s44, v1
    v_mul_f32 v2, s44, v2
    v_mul_f32 v3, s44, v3
    v_mul_f32 v4, s45, v4
    v_mul_f32 v5, s45, v5
    v_mul_f32 v6, s45, v6
    v_mul_f32 v7, s45, v7
    v_mul_f32 v8, s44, v8
    v_mul_f32 v9, s44, v9
    v_mul_f32 v10, s44, v10
    v_mul_f32 v11, s44, v11
    v_mul_f32 v12, s45, v12
    v_mul_f32 v13, s45, v13
    v_mul_f32 v14, s45, v14
    v_mul_f32 v15, s45, v15
    v_mul_f32 v16, s44, v16
    v_mul_f32 v17, s44, v17
    v_mul_f32 v18, s44, v18
    v_mul_f32 v19, s44, v19
    v_mul_f32 v20, s45, v20
    v_mul_f32 v21, s45, v21
    v_mul_f32 v22, s45, v22
    v_mul_f32 v23, s45, v23
    v_mul_f32 v24, s44, v24
    v_mul_f32 v25, s44, v25
    v_mul_f32 v26, s44, v26
    v_mul_f32 v27, s44, v27
    v_mul_f32 v28, s45, v28
    v_mul_f32 v29, s45, v29
    v_mul_f32 v30, s45, v30
    v_mul_f32 v31, s45, v31
    v_mul_f32 v32, s44, v32
    v_mul_f32 v33, s44, v33
    v_mul_f32 v34, s44, v34
    v_mul_f32 v35, s44, v35
    v_mul_f32 v36, s45, v36
    v_mul_f32 v37, s45, v37
    v_mul_f32 v38, s45, v38
    v_mul_f32 v39, s45, v39
    v_mul_f32 v40, s44, v40
    v_mul_f32 v41, s44, v41
    v_mul_f32 v42, s44, v42
    v_mul_f32 v43, s44, v43
    v_mul_f32 v44, s45, v44
    v_mul_f32 v45, s45, v45
    v_mul_f32 v46, s45, v46
    v_mul_f32 v47, s45, v47
    v_mul_f32 v48, s44, v48
    v_mul_f32 v49, s44, v49
    v_mul_f32 v50, s44, v50
    v_mul_f32 v51, s44, v51
    v_mul_f32 v52, s45, v52
    v_mul_f32 v53, s45, v53
    v_mul_f32 v54, s45, v54
    v_mul_f32 v55, s45, v55
    v_mul_f32 v56, s44, v56
    v_mul_f32 v57, s44, v57
    v_mul_f32 v58, s44, v58
    v_mul_f32 v59, s44, v59
    v_mul_f32 v60, s45, v60
    v_mul_f32 v61, s45, v61
    v_mul_f32 v62, s45, v62
    v_mul_f32 v63, s45, v63
    v_mul_f32 v64, s44, v64
    v_mul_f32 v65, s44, v65
    v_mul_f32 v66, s44, v66
    v_mul_f32 v67, s44, v67
    v_mul_f32 v68, s45, v68
    v_mul_f32 v69, s45, v69
    v_mul_f32 v70, s45, v70
    v_mul_f32 v71, s45, v71
    v_mul_f32 v72, s44, v72
    v_mul_f32 v73, s44, v73
    v_mul_f32 v74, s44, v74
    v_mul_f32 v75, s44, v75
    v_mul_f32 v76, s45, v76
    v_mul_f32 v77, s45, v77
    v_mul_f32 v78, s45, v78
    v_mul_f32 v79, s45, v79
    v_mul_f32 v80, s44, v80
    v_mul_f32 v81, s44, v81
    v_mul_f32 v82, s44, v82
    v_mul_f32 v83, s44, v83
    v_mul_f32 v84, s45, v84
    v_mul_f32 v85, s45, v85
    v_mul_f32 v86, s45, v86
    v_mul_f32 v87, s45, v87
    v_mul_f32 v88, s44, v88
    v_mul_f32 v89, s44, v89
    v_mul_f32 v90, s44, v90
    v_mul_f32 v91, s44, v91
    v_mul_f32 v92, s45, v92
    v_mul_f32 v93, s45, v93
    v_mul_f32 v94, s45, v94
    v_mul_f32 v95, s45, v95
    v_mul_f32 v96, s44, v96
    v_mul_f32 v97, s44, v97
    v_mul_f32 v98, s44, v98
    v_mul_f32 v99, s44, v99
    v_mul_f32 v100, s45, v100
    v_mul_f32 v101, s45, v101
    v_mul_f32 v102, s45, v102
    v_mul_f32 v103, s45, v103
    v_mul_f32 v104, s44, v104
    v_mul_f32 v105, s44, v105
    v_mul_f32 v106, s44, v106
    v_mul_f32 v107, s44, v107
    v_mul_f32 v108, s45, v108
    v_mul_f32 v109, s45, v109
    v_mul_f32 v110, s45, v110
    v_mul_f32 v111, s45, v111
    v_mul_f32 v112, s44, v112
    v_mul_f32 v113, s44, v113
    v_mul_f32 v114, s44, v114
    v_mul_f32 v115, s44, v115
    v_mul_f32 v116, s45, v116
    v_mul_f32 v117, s45, v117
    v_mul_f32 v118, s45, v118
    v_mul_f32 v119, s45, v119
    v_mul_f32 v120, s44, v120
    v_mul_f32 v121, s44, v121
    v_mul_f32 v122, s44, v122
    v_mul_f32 v123, s44, v123
    v_mul_f32 v124, s45, v124
    v_mul_f32 v125, s45, v125
    v_mul_f32 v126, s45, v126
    v_mul_f32 v127, s45, v127
    s_nop 7
    s_branch L_RB11
L_RS12:
    s_nop 7
    s_nop 7
    v_readlane_b32 s44, v255, 4
    v_readlane_b32 s45, v255, 12
    s_add_i32 s44, s44, 127
    s_lshl_b32 s44, s44, 23
    s_add_i32 s45, s45, 127
    s_lshl_b32 s45, s45, 23
    v_mul_f32 v0, s44, v0
    v_mul_f32 v1, s44, v1
    v_mul_f32 v2, s44, v2
    v_mul_f32 v3, s44, v3
    v_mul_f32 v4, s45, v4
    v_mul_f32 v5, s45, v5
    v_mul_f32 v6, s45, v6
    v_mul_f32 v7, s45, v7
    v_mul_f32 v8, s44, v8
    v_mul_f32 v9, s44, v9
    v_mul_f32 v10, s44, v10
    v_mul_f32 v11, s44, v11
    v_mul_f32 v12, s45, v12
    v_mul_f32 v13, s45, v13
    v_mul_f32 v14, s45, v14
    v_mul_f32 v15, s45, v15
    v_mul_f32 v16, s44, v16
    v_mul_f32 v17, s44, v17
    v_mul_f32 v18, s44, v18
    v_mul_f32 v19, s44, v19
    v_mul_f32 v20, s45, v20
    v_mul_f32 v21, s45, v21
    v_mul_f32 v22, s45, v22
    v_mul_f32 v23, s45, v23
    v_mul_f32 v24, s44, v24
    v_mul_f32 v25, s44, v25
    v_mul_f32 v26, s44, v26
    v_mul_f32 v27, s44, v27
    v_mul_f32 v28, s45, v28
    v_mul_f32 v29, s45, v29
    v_mul_f32 v30, s45, v30
    v_mul_f32 v31, s45, v31
    v_mul_f32 v32, s44, v32
    v_mul_f32 v33, s44, v33
    v_mul_f32 v34, s44, v34
    v_mul_f32 v35, s44, v35
    v_mul_f32 v36, s45, v36
    v_mul_f32 v37, s45, v37
    v_mul_f32 v38, s45, v38
    v_mul_f32 v39, s45, v39
    v_mul_f32 v40, s44, v40
    v_mul_f32 v41, s44, v41
    v_mul_f32 v42, s44, v42
    v_mul_f32 v43, s44, v43
    v_mul_f32 v44, s45, v44
    v_mul_f32 v45, s45, v45
    v_mul_f32 v46, s45, v46
    v_mul_f32 v47, s45, v47
    v_mul_f32 v48, s44, v48
    v_mul_f32 v49, s44, v49
    v_mul_f32 v50, s44, v50
    v_mul_f32 v51, s44, v51
    v_mul_f32 v52, s45, v52
    v_mul_f32 v53, s45, v53
    v_mul_f32 v54, s45, v54
    v_mul_f32 v55, s45, v55
    v_mul_f32 v56, s44, v56
    v_mul_f32 v57, s44, v57
    v_mul_f32 v58, s44, v58
    v_mul_f32 v59, s44, v59
    v_mul_f32 v60, s45, v60
    v_mul_f32 v61, s45, v61
    v_mul_f32 v62, s45, v62
    v_mul_f32 v63, s45, v63
    v_mul_f32 v64, s44, v64
    v_mul_f32 v65, s44, v65
    v_mul_f32 v66, s44, v66
    v_mul_f32 v67, s44, v67
    v_mul_f32 v68, s45, v68
    v_mul_f32 v69, s45, v69
    v_mul_f32 v70, s45, v70
    v_mul_f32 v71, s45, v71
    v_mul_f32 v72, s44, v72
    v_mul_f32 v73, s44, v73
    v_mul_f32 v74, s44, v74
    v_mul_f32 v75, s44, v75
    v_mul_f32 v76, s45, v76
    v_mul_f32 v77, s45, v77
    v_mul_f32 v78, s45, v78
    v_mul_f32 v79, s45, v79
    v_mul_f32 v80, s44, v80
    v_mul_f32 v81, s44, v81
    v_mul_f32 v82, s44, v82
    v_mul_f32 v83, s44, v83
    v_mul_f32 v84, s45, v84
    v_mul_f32 v85, s45, v85
    v_mul_f32 v86, s45, v86
    v_mul_f32 v87, s45, v87
    v_mul_f32 v88, s44, v88
    v_mul_f32 v89, s44, v89
    v_mul_f32 v90, s44, v90
    v_mul_f32 v91, s44, v91
    v_mul_f32 v92, s45, v92
    v_mul_f32 v93, s45, v93
    v_mul_f32 v94, s45, v94
    v_mul_f32 v95, s45, v95
    v_mul_f32 v96, s44, v96
    v_mul_f32 v97, s44, v97
    v_mul_f32 v98, s44, v98
    v_mul_f32 v99, s44, v99
    v_mul_f32 v100, s45, v100
    v_mul_f32 v101, s45, v101
    v_mul_f32 v102, s45, v102
    v_mul_f32 v103, s45, v103
    v_mul_f32 v104, s44, v104
    v_mul_f32 v105, s44, v105
    v_mul_f32 v106, s44, v106
    v_mul_f32 v107, s44, v107
    v_mul_f32 v108, s45, v108
    v_mul_f32 v109, s45, v109
    v_mul_f32 v110, s45, v110
    v_mul_f32 v111, s45, v111
    v_mul_f32 v112, s44, v112
    v_mul_f32 v113, s44, v113
    v_mul_f32 v114, s44, v114
    v_mul_f32 v115, s44, v115
    v_mul_f32 v116, s45, v116
    v_mul_f32 v117, s45, v117
    v_mul_f32 v118, s45, v118
    v_mul_f32 v119, s45, v119
    v_mul_f32 v120, s44, v120
    v_mul_f32 v121, s44, v121
    v_mul_f32 v122, s44, v122
    v_mul_f32 v123, s44, v123
    v_mul_f32 v124, s45, v124
    v_mul_f32 v125, s45, v125
    v_mul_f32 v126, s45, v126
    v_mul_f32 v127, s45, v127
    s_nop 7
    s_branch L_RB12
L_RS13:
    s_nop 7
    s_nop 7
    v_readlane_b32 s44, v255, 5
    v_readlane_b32 s45, v255, 13
    s_add_i32 s44, s44, 127
    s_lshl_b32 s44, s44, 23
    s_add_i32 s45, s45, 127
    s_lshl_b32 s45, s45, 23
    v_mul_f32 v0, s44, v0
    v_mul_f32 v1, s44, v1
    v_mul_f32 v2, s44, v2
    v_mul_f32 v3, s44, v3
    v_mul_f32 v4, s45, v4
    v_mul_f32 v5, s45, v5
    v_mul_f32 v6, s45, v6
    v_mul_f32 v7, s45, v7
    v_mul_f32 v8, s44, v8
    v_mul_f32 v9, s44, v9
    v_mul_f32 v10, s44, v10
    v_mul_f32 v11, s44, v11
    v_mul_f32 v12, s45, v12
    v_mul_f32 v13, s45, v13
    v_mul_f32 v14, s45, v14
    v_mul_f32 v15, s45, v15
    v_mul_f32 v16, s44, v16
    v_mul_f32 v17, s44, v17
    v_mul_f32 v18, s44, v18
    v_mul_f32 v19, s44, v19
    v_mul_f32 v20, s45, v20
    v_mul_f32 v21, s45, v21
    v_mul_f32 v22, s45, v22
    v_mul_f32 v23, s45, v23
    v_mul_f32 v24, s44, v24
    v_mul_f32 v25, s44, v25
    v_mul_f32 v26, s44, v26
    v_mul_f32 v27, s44, v27
    v_mul_f32 v28, s45, v28
    v_mul_f32 v29, s45, v29
    v_mul_f32 v30, s45, v30
    v_mul_f32 v31, s45, v31
    v_mul_f32 v32, s44, v32
    v_mul_f32 v33, s44, v33
    v_mul_f32 v34, s44, v34
    v_mul_f32 v35, s44, v35
    v_mul_f32 v36, s45, v36
    v_mul_f32 v37, s45, v37
    v_mul_f32 v38, s45, v38
    v_mul_f32 v39, s45, v39
    v_mul_f32 v40, s44, v40
    v_mul_f32 v41, s44, v41
    v_mul_f32 v42, s44, v42
    v_mul_f32 v43, s44, v43
    v_mul_f32 v44, s45, v44
    v_mul_f32 v45, s45, v45
    v_mul_f32 v46, s45, v46
    v_mul_f32 v47, s45, v47
    v_mul_f32 v48, s44, v48
    v_mul_f32 v49, s44, v49
    v_mul_f32 v50, s44, v50
    v_mul_f32 v51, s44, v51
    v_mul_f32 v52, s45, v52
    v_mul_f32 v53, s45, v53
    v_mul_f32 v54, s45, v54
    v_mul_f32 v55, s45, v55
    v_mul_f32 v56, s44, v56
    v_mul_f32 v57, s44, v57
    v_mul_f32 v58, s44, v58
    v_mul_f32 v59, s44, v59
    v_mul_f32 v60, s45, v60
    v_mul_f32 v61, s45, v61
    v_mul_f32 v62, s45, v62
    v_mul_f32 v63, s45, v63
    v_mul_f32 v64, s44, v64
    v_mul_f32 v65, s44, v65
    v_mul_f32 v66, s44, v66
    v_mul_f32 v67, s44, v67
    v_mul_f32 v68, s45, v68
    v_mul_f32 v69, s45, v69
    v_mul_f32 v70, s45, v70
    v_mul_f32 v71, s45, v71
    v_mul_f32 v72, s44, v72
    v_mul_f32 v73, s44, v73
    v_mul_f32 v74, s44, v74
    v_mul_f32 v75, s44, v75
    v_mul_f32 v76, s45, v76
    v_mul_f32 v77, s45, v77
    v_mul_f32 v78, s45, v78
    v_mul_f32 v79, s45, v79
    v_mul_f32 v80, s44, v80
    v_mul_f32 v81, s44, v81
    v_mul_f32 v82, s44, v82
    v_mul_f32 v83, s44, v83
    v_mul_f32 v84, s45, v84
    v_mul_f32 v85, s45, v85
    v_mul_f32 v86, s45, v86
    v_mul_f32 v87, s45, v87
    v_mul_f32 v88, s44, v88
    v_mul_f32 v89, s44, v89
    v_mul_f32 v90, s44, v90
    v_mul_f32 v91, s44, v91
    v_mul_f32 v92, s45, v92
    v_mul_f32 v93, s45, v93
    v_mul_f32 v94, s45, v94
    v_mul_f32 v95, s45, v95
    v_mul_f32 v96, s44, v96
    v_mul_f32 v97, s44, v97
    v_mul_f32 v98, s44, v98
    v_mul_f32 v99, s44, v99
    v_mul_f32 v100, s45, v100
    v_mul_f32 v101, s45, v101
    v_mul_f32 v102, s45, v102
    v_mul_f32 v103, s45, v103
    v_mul_f32 v104, s44, v104
    v_mul_f32 v105, s44, v105
    v_mul_f32 v106, s44, v106
    v_mul_f32 v107, s44, v107
    v_mul_f32 v108, s45, v108
    v_mul_f32 v109, s45, v109
    v_mul_f32 v110, s45, v110
    v_mul_f32 v111, s45, v111
    v_mul_f32 v112, s44, v112
    v_mul_f32 v113, s44, v113
    v_mul_f32 v114, s44, v114
    v_mul_f32 v115, s44, v115
    v_mul_f32 v116, s45, v116
    v_mul_f32 v117, s45, v117
    v_mul_f32 v118, s45, v118
    v_mul_f32 v119, s45, v119
    v_mul_f32 v120, s44, v120
    v_mul_f32 v121, s44, v121
    v_mul_f32 v122, s44, v122
    v_mul_f32 v123, s44, v123
    v_mul_f32 v124, s45, v124
    v_mul_f32 v125, s45, v125
    v_mul_f32 v126, s45, v126
    v_mul_f32 v127, s45, v127
    s_nop 7
    s_branch L_RB13
L_RS14:
    s_nop 7
    s_nop 7
    v_readlane_b32 s44, v255, 6
    v_readlane_b32 s45, v255, 14
    s_add_i32 s44, s44, 127
    s_lshl_b32 s44, s44, 23
    s_add_i32 s45, s45, 127
    s_lshl_b32 s45, s45, 23
    v_mul_f32 v0, s44, v0
    v_mul_f32 v1, s44, v1
    v_mul_f32 v2, s44, v2
    v_mul_f32 v3, s44, v3
    v_mul_f32 v4, s45, v4
    v_mul_f32 v5, s45, v5
    v_mul_f32 v6, s45, v6
    v_mul_f32 v7, s45, v7
    v_mul_f32 v8, s44, v8
    v_mul_f32 v9, s44, v9
    v_mul_f32 v10, s44, v10
    v_mul_f32 v11, s44, v11
    v_mul_f32 v12, s45, v12
    v_mul_f32 v13, s45, v13
    v_mul_f32 v14, s45, v14
    v_mul_f32 v15, s45, v15
    v_mul_f32 v16, s44, v16
    v_mul_f32 v17, s44, v17
    v_mul_f32 v18, s44, v18
    v_mul_f32 v19, s44, v19
    v_mul_f32 v20, s45, v20
    v_mul_f32 v21, s45, v21
    v_mul_f32 v22, s45, v22
    v_mul_f32 v23, s45, v23
    v_mul_f32 v24, s44, v24
    v_mul_f32 v25, s44, v25
    v_mul_f32 v26, s44, v26
    v_mul_f32 v27, s44, v27
    v_mul_f32 v28, s45, v28
    v_mul_f32 v29, s45, v29
    v_mul_f32 v30, s45, v30
    v_mul_f32 v31, s45, v31
    v_mul_f32 v32, s44, v32
    v_mul_f32 v33, s44, v33
    v_mul_f32 v34, s44, v34
    v_mul_f32 v35, s44, v35
    v_mul_f32 v36, s45, v36
    v_mul_f32 v37, s45, v37
    v_mul_f32 v38, s45, v38
    v_mul_f32 v39, s45, v39
    v_mul_f32 v40, s44, v40
    v_mul_f32 v41, s44, v41
    v_mul_f32 v42, s44, v42
    v_mul_f32 v43, s44, v43
    v_mul_f32 v44, s45, v44
    v_mul_f32 v45, s45, v45
    v_mul_f32 v46, s45, v46
    v_mul_f32 v47, s45, v47
    v_mul_f32 v48, s44, v48
    v_mul_f32 v49, s44, v49
    v_mul_f32 v50, s44, v50
    v_mul_f32 v51, s44, v51
    v_mul_f32 v52, s45, v52
    v_mul_f32 v53, s45, v53
    v_mul_f32 v54, s45, v54
    v_mul_f32 v55, s45, v55
    v_mul_f32 v56, s44, v56
    v_mul_f32 v57, s44, v57
    v_mul_f32 v58, s44, v58
    v_mul_f32 v59, s44, v59
    v_mul_f32 v60, s45, v60
    v_mul_f32 v61, s45, v61
    v_mul_f32 v62, s45, v62
    v_mul_f32 v63, s45, v63
    v_mul_f32 v64, s44, v64
    v_mul_f32 v65, s44, v65
    v_mul_f32 v66, s44, v66
    v_mul_f32 v67, s44, v67
    v_mul_f32 v68, s45, v68
    v_mul_f32 v69, s45, v69
    v_mul_f32 v70, s45, v70
    v_mul_f32 v71, s45, v71
    v_mul_f32 v72, s44, v72
    v_mul_f32 v73, s44, v73
    v_mul_f32 v74, s44, v74
    v_mul_f32 v75, s44, v75
    v_mul_f32 v76, s45, v76
    v_mul_f32 v77, s45, v77
    v_mul_f32 v78, s45, v78
    v_mul_f32 v79, s45, v79
    v_mul_f32 v80, s44, v80
    v_mul_f32 v81, s44, v81
    v_mul_f32 v82, s44, v82
    v_mul_f32 v83, s44, v83
    v_mul_f32 v84, s45, v84
    v_mul_f32 v85, s45, v85
    v_mul_f32 v86, s45, v86
    v_mul_f32 v87, s45, v87
    v_mul_f32 v88, s44, v88
    v_mul_f32 v89, s44, v89
    v_mul_f32 v90, s44, v90
    v_mul_f32 v91, s44, v91
    v_mul_f32 v92, s45, v92
    v_mul_f32 v93, s45, v93
    v_mul_f32 v94, s45, v94
    v_mul_f32 v95, s45, v95
    v_mul_f32 v96, s44, v96
    v_mul_f32 v97, s44, v97
    v_mul_f32 v98, s44, v98
    v_mul_f32 v99, s44, v99
    v_mul_f32 v100, s45, v100
    v_mul_f32 v101, s45, v101
    v_mul_f32 v102, s45, v102
    v_mul_f32 v103, s45, v103
    v_mul_f32 v104, s44, v104
    v_mul_f32 v105, s44, v105
    v_mul_f32 v106, s44, v106
    v_mul_f32 v107, s44, v107
    v_mul_f32 v108, s45, v108
    v_mul_f32 v109, s45, v109
    v_mul_f32 v110, s45, v110
    v_mul_f32 v111, s45, v111
    v_mul_f32 v112, s44, v112
    v_mul_f32 v113, s44, v113
    v_mul_f32 v114, s44, v114
    v_mul_f32 v115, s44, v115
    v_mul_f32 v116, s45, v116
    v_mul_f32 v117, s45, v117
    v_mul_f32 v118, s45, v118
    v_mul_f32 v119, s45, v119
    v_mul_f32 v120, s44, v120
    v_mul_f32 v121, s44, v121
    v_mul_f32 v122, s44, v122
    v_mul_f32 v123, s44, v123
    v_mul_f32 v124, s45, v124
    v_mul_f32 v125, s45, v125
    v_mul_f32 v126, s45, v126
    v_mul_f32 v127, s45, v127
    s_nop 7
    s_branch L_RB14
L_RS15:
    s_nop 7
    s_nop 7
    v_readlane_b32 s44, v255, 7
    v_readlane_b32 s45, v255, 15
    s_add_i32 s44, s44, 127
    s_lshl_b32 s44, s44, 23
    s_add_i32 s45, s45, 127
    s_lshl_b32 s45, s45, 23
    v_mul_f32 v0, s44, v0
    v_mul_f32 v1, s44, v1
    v_mul_f32 v2, s44, v2
    v_mul_f32 v3, s44, v3
    v_mul_f32 v4, s45, v4
    v_mul_f32 v5, s45, v5
    v_mul_f32 v6, s45, v6
    v_mul_f32 v7, s45, v7
    v_mul_f32 v8, s44, v8
    v_mul_f32 v9, s44, v9
    v_mul_f32 v10, s44, v10
    v_mul_f32 v11, s44, v11
    v_mul_f32 v12, s45, v12
    v_mul_f32 v13, s45, v13
    v_mul_f32 v14, s45, v14
    v_mul_f32 v15, s45, v15
    v_mul_f32 v16, s44, v16
    v_mul_f32 v17, s44, v17
    v_mul_f32 v18, s44, v18
    v_mul_f32 v19, s44, v19
    v_mul_f32 v20, s45, v20
    v_mul_f32 v21, s45, v21
    v_mul_f32 v22, s45, v22
    v_mul_f32 v23, s45, v23
    v_mul_f32 v24, s44, v24
    v_mul_f32 v25, s44, v25
    v_mul_f32 v26, s44, v26
    v_mul_f32 v27, s44, v27
    v_mul_f32 v28, s45, v28
    v_mul_f32 v29, s45, v29
    v_mul_f32 v30, s45, v30
    v_mul_f32 v31, s45, v31
    v_mul_f32 v32, s44, v32
    v_mul_f32 v33, s44, v33
    v_mul_f32 v34, s44, v34
    v_mul_f32 v35, s44, v35
    v_mul_f32 v36, s45, v36
    v_mul_f32 v37, s45, v37
    v_mul_f32 v38, s45, v38
    v_mul_f32 v39, s45, v39
    v_mul_f32 v40, s44, v40
    v_mul_f32 v41, s44, v41
    v_mul_f32 v42, s44, v42
    v_mul_f32 v43, s44, v43
    v_mul_f32 v44, s45, v44
    v_mul_f32 v45, s45, v45
    v_mul_f32 v46, s45, v46
    v_mul_f32 v47, s45, v47
    v_mul_f32 v48, s44, v48
    v_mul_f32 v49, s44, v49
    v_mul_f32 v50, s44, v50
    v_mul_f32 v51, s44, v51
    v_mul_f32 v52, s45, v52
    v_mul_f32 v53, s45, v53
    v_mul_f32 v54, s45, v54
    v_mul_f32 v55, s45, v55
    v_mul_f32 v56, s44, v56
    v_mul_f32 v57, s44, v57
    v_mul_f32 v58, s44, v58
    v_mul_f32 v59, s44, v59
    v_mul_f32 v60, s45, v60
    v_mul_f32 v61, s45, v61
    v_mul_f32 v62, s45, v62
    v_mul_f32 v63, s45, v63
    v_mul_f32 v64, s44, v64
    v_mul_f32 v65, s44, v65
    v_mul_f32 v66, s44, v66
    v_mul_f32 v67, s44, v67
    v_mul_f32 v68, s45, v68
    v_mul_f32 v69, s45, v69
    v_mul_f32 v70, s45, v70
    v_mul_f32 v71, s45, v71
    v_mul_f32 v72, s44, v72
    v_mul_f32 v73, s44, v73
    v_mul_f32 v74, s44, v74
    v_mul_f32 v75, s44, v75
    v_mul_f32 v76, s45, v76
    v_mul_f32 v77, s45, v77
    v_mul_f32 v78, s45, v78
    v_mul_f32 v79, s45, v79
    v_mul_f32 v80, s44, v80
    v_mul_f32 v81, s44, v81
    v_mul_f32 v82, s44, v82
    v_mul_f32 v83, s44, v83
    v_mul_f32 v84, s45, v84
    v_mul_f32 v85, s45, v85
    v_mul_f32 v86, s45, v86
    v_mul_f32 v87, s45, v87
    v_mul_f32 v88, s44, v88
    v_mul_f32 v89, s44, v89
    v_mul_f32 v90, s44, v90
    v_mul_f32 v91, s44, v91
    v_mul_f32 v92, s45, v92
    v_mul_f32 v93, s45, v93
    v_mul_f32 v94, s45, v94
    v_mul_f32 v95, s45, v95
    v_mul_f32 v96, s44, v96
    v_mul_f32 v97, s44, v97
    v_mul_f32 v98, s44, v98
    v_mul_f32 v99, s44, v99
    v_mul_f32 v100, s45, v100
    v_mul_f32 v101, s45, v101
    v_mul_f32 v102, s45, v102
    v_mul_f32 v103, s45, v103
    v_mul_f32 v104, s44, v104
    v_mul_f32 v105, s44, v105
    v_mul_f32 v106, s44, v106
    v_mul_f32 v107, s44, v107
    v_mul_f32 v108, s45, v108
    v_mul_f32 v109, s45, v109
    v_mul_f32 v110, s45, v110
    v_mul_f32 v111, s45, v111
    v_mul_f32 v112, s44, v112
    v_mul_f32 v113, s44, v113
    v_mul_f32 v114, s44, v114
    v_mul_f32 v115, s44, v115
    v_mul_f32 v116, s45, v116
    v_mul_f32 v117, s45, v117
    v_mul_f32 v118, s45, v118
    v_mul_f32 v119, s45, v119
    v_mul_f32 v120, s44, v120
    v_mul_f32 v121, s44, v121
    v_mul_f32 v122, s44, v122
    v_mul_f32 v123, s44, v123
    v_mul_f32 v124, s45, v124
    v_mul_f32 v125, s45, v125
    v_mul_f32 v126, s45, v126
    v_mul_f32 v127, s45, v127
    s_nop 7
    s_branch L_RB15
.section .rodata,"a"
.p2align 6
.amdhsa_kernel standalone__autoregressive_conv_wavenet__speech_kernel
  .amdhsa_next_free_vgpr 256
  .amdhsa_next_free_sgpr 102
  .amdhsa_accum_offset 256
  .amdhsa_group_segment_fixed_size 0
  .amdhsa_kernarg_size 48
  .amdhsa_user_sgpr_count 2
  .amdhsa_user_sgpr_kernarg_segment_ptr 1
  .amdhsa_system_sgpr_workgroup_id_x 1
.end_amdhsa_kernel
```
